```python
import torch

def _softmax(x, axis=-1):
    return torch.softmax(x, dim=axis)

def _gelu(x):
    return torch.nn.functional.gelu(x, approximate='tanh')

def _silu(x):
    return torch.nn.functional.silu(x)

def _sigmoid(x):
    return torch.sigmoid(x)

def _layernorm(x, axis=-1, eps=1e-05):
    m = x.mean(dim=axis, keepdim=True)
    v = x.var(dim=axis, keepdim=True, unbiased=False)
    return (x - m) / torch.sqrt(v + eps)

def _scatter_add(tgt, idx, src, axis=0):
    return tgt.clone().index_add_(axis, idx, src)

def _segment_sum(src, seg, n):
    out = torch.zeros((n,) + src.shape[1:], dtype=src.dtype)
    return out.index_add_(0, seg, src)

def _pad(x, pw):
    flat = tuple((v for pair in reversed(pw) for v in pair))
    return torch.nn.functional.pad(x, flat)
kernel_name = 'adaLN_cond__gqa_block_cached__mixer_channel_mlp__decode'

def setup_inputs():

    _w = lambda a: (lambda t: t.to(torch.bfloat16) if t.is_floating_point() else t)(torch.as_tensor(a))

    def _A_setup():
        B, Sq, D = (2, 1, 512)
        Hq, Hkv, Sk, Dh = (32, 8, 8192, 128)
        assert Hq % Hkv == 0, (Hq, Hkv)
        return {'x': _w((lambda *s: torch.randn(*s, dtype=torch.bfloat16) * 0.1)(B, Sq, D)), 'k_cache': _w((lambda *s: torch.randn(*s, dtype=torch.bfloat16) * 0.8)(B, Hkv, Sk, Dh)), 'v_cache': _w((lambda *s: torch.randn(*s, dtype=torch.bfloat16) * 0.8)(B, Hkv, Sk, Dh)), 'wq': _w((lambda *s: torch.randn(*s, dtype=torch.bfloat16) * 0.8)(D, Hq * Dh) * D ** (-0.5)), 'wo': _w((lambda *s: torch.randn(*s, dtype=torch.bfloat16) * 0.8)(Hq * Dh, D) * (Hq * Dh) ** (-0.5))}
    _A_in = _A_setup()

    def _B_setup():
        B, S, D, F = (2, 1, 512, 1792)
        return {'x': _w((lambda *s: torch.randn(*s, dtype=torch.bfloat16) * 0.1)(B, S, D)), 'w1': _w((lambda *s: torch.randn(*s, dtype=torch.bfloat16) * 3.2)(D, F) * D ** (-0.5)), 'b1': _w((lambda *s: torch.randn(*s, dtype=torch.bfloat16) * 3.2)(F)), 'w2': _w((lambda *s: torch.randn(*s, dtype=torch.bfloat16) * 3.2)(F, D) * F ** (-0.5)), 'b2': _w((lambda *s: torch.randn(*s, dtype=torch.bfloat16) * 3.2)(D))}
    _B_in = _B_setup()
    return {'A_x': _A_in['x'], 'A_k_cache': _A_in['k_cache'], 'A_v_cache': _A_in['v_cache'], 'A_wq': _A_in['wq'], 'A_wo': _A_in['wo'], 'B_x': _B_in['x'], 'B_w1': _B_in['w1'], 'B_b1': _B_in['b1'], 'B_w2': _B_in['w2'], 'B_b2': _B_in['b2'], 'c': _w((lambda *s: torch.randn(*s, dtype=torch.bfloat16) * 0.4)(2, 512) * 8.0), 'w_mod': _w((lambda *s: torch.randn(*s, dtype=torch.bfloat16) * 0.4)(512, 6 * 512) * 512 ** (-0.5) * 8.0)}

def reference(A_x, A_k_cache, A_v_cache, A_wq, A_wo, B_x, B_w1, B_b1, B_w2, B_b2, c, w_mod):

    def _A_ref(x, k_cache, v_cache, wq, wo):
        B, Sq, D = x.shape
        Hq, Dh = (32, 128)
        Hkv = k_cache.shape[1]
        rep = Hq // Hkv
        q = (lambda x, *d: x.permute(*d))((x @ wq).reshape(B, Sq, Hq, Dh), 0, 2, 1, 3)
        k = (lambda x, n, axis: torch.repeat_interleave(x, n, dim=axis))(k_cache, rep, axis=1)
        v = (lambda x, n, axis: torch.repeat_interleave(x, n, dim=axis))(v_cache, rep, axis=1)
        scores = torch.einsum('bhqd,bhkd->bhqk', q, k) * Dh ** (-0.5)
        p = _softmax(scores, axis=-1)
        o = torch.einsum('bhqk,bhkd->bhqd', p, v)
        return (lambda x, *d: x.permute(*d))(o, 0, 2, 1, 3).reshape(B, Sq, Hq * Dh) @ wo

    def _B_ref(x, w1, b1, w2, b2):
        y = _layernorm(x, axis=-1)
        h = _gelu(torch.einsum('bsd,df->bsf', y, w1) + b1)
        return torch.einsum('bsf,fd->bsd', h, w2) + b2
    x = A_x
    mod = (_silu(c) @ w_mod).reshape(c.shape[0], 6, 1, -1)
    sa, ca, ga, sb, cb, gb = (mod[:, 0].clone(), mod[:, 1].clone(), mod[:, 2].clone(), mod[:, 3].clone(), mod[:, 4].clone(), mod[:, 5].clone())
    h = _layernorm(x, axis=-1) * (1 + ca) + sa
    x = x + ga * _A_ref(h, A_k_cache, A_v_cache, A_wq, A_wo)
    h = _layernorm(x, axis=-1) * (1 + cb) + sb
    x = x + gb * _B_ref(h, B_w1, B_b1, B_w2, B_b2)
    return x
```

```asm
; @launch grid=(256,1,1) block=(768,1,1) lds=101440
.amdgcn_target "amdgcn-amd-amdhsa--gfx950"
.text
.globl adaLN_cond__gqa_block_cached__mixer_channel_mlp__decode_kernel
.p2align 8
.type adaLN_cond__gqa_block_cached__mixer_channel_mlp__decode_kernel,@function
adaLN_cond__gqa_block_cached__mixer_channel_mlp__decode_kernel:
s_cmp_ge_u32 s2, 256
s_cbranch_scc1 L_exit
s_load_dwordx2 s[8:9], s[0:1], 8
s_load_dwordx2 s[12:13], s[0:1], 16
s_load_dwordx2 s[16:17], s[0:1], 112
s_load_dwordx2 s[20:21], s[0:1], 104
s_mov_b32 s10, 0x2000000
s_mov_b32 s11, 0x20000
s_mov_b32 s14, 0x2000000
s_mov_b32 s15, 0x20000
s_mov_b32 s18, 0x400000
s_mov_b32 s19, 0x20000
s_mov_b32 s22, 0x100
s_mov_b32 s23, 0x20000
s_load_dwordx2 s[56:57], s[0:1], 88
s_load_dwordx2 s[52:53], s[0:1], 80
s_load_dwordx2 s[28:29], s[0:1], 24
v_lshrrev_b32 v2, 6, v0
v_and_b32 v1, 63, v0
v_readfirstlane_b32 s3, v2
s_and_b32 s5, s2, 7
s_lshr_b32 s4, s2, 3
s_lshl_b32 s6, s5, 4
s_sub_u32 s6, s3, s6
s_cmp_ge_i32 s6, 8
s_cbranch_scc1 L_tail_c
s_cmp_eq_u32 s5, 0
s_cbranch_scc1 L_tail
s_mul_i32 s6, s4, 37
s_lshr_b32 s6, s6, 8
s_mul_i32 s6, s6, 7
s_sub_u32 s6, s4, s6
s_add_u32 s6, s6, 1
s_cmp_eq_u32 s5, s6
s_cbranch_scc1 L_h_q
s_cmp_gt_u32 s5, s6
s_cselect_b32 s6, 2, 1
s_mul_i32 s4, s4, 6
s_add_u32 s4, s4, s5
s_sub_u32 s4, s4, s6
s_mov_b32 s5, 0x15555556
s_mul_hi_u32 s80, s4, s5
s_mul_i32 s5, s80, 12
s_sub_u32 s81, s4, s5
s_cmp_lt_u32 s81, 8
s_cselect_b32 s82, 11, 10
s_cmp_ge_u32 s3, 11
s_cbranch_scc1 L_att_ctl
s_cmp_ge_u32 s3, s82
s_cbranch_scc1 L_exit
s_min_u32 s5, s81, 8
s_mul_i32 s6, s81, 10
s_add_u32 s5, s5, s6
s_lshl_b32 s5, s5, 14
s_lshl_b32 s6, s80, 21
s_add_u32 s5, s5, s6
s_lshl_b32 s6, s3, 10
s_add_u32 s83, s5, s6
s_lshl_b32 s84, s82, 10
v_bfe_u32 v3, v1, 2, 2
v_lshlrev_b32 v3, 8, v3
v_lshrrev_b32 v4, 4, v1
v_lshl_add_u32 v3, v4, 6, v3
v_and_b32 v4, 3, v1
v_lshl_add_u32 v3, v4, 4, v3
v_lshlrev_b32 v2, 4, v1
s_mov_b32 s85, s83
s_waitcnt lgkmcnt(0)
buffer_load_dwordx4 v[32:35], v3, s[8:11], s85 offen nt
s_add_u32 s85, s85, s84
buffer_load_dwordx4 v[36:39], v3, s[8:11], s85 offen nt
s_add_u32 s85, s85, s84
s_mov_b32 s64, 0xf000f
s_mov_b32 s65, 0xf000f
s_mov_b32 s66, 0xf000f0
s_mov_b32 s67, 0xf000f0
s_mov_b32 s68, 0xf000f00
s_mov_b32 s69, 0xf000f00
s_mov_b32 s70, 0xf000f000
s_mov_b32 s71, 0xf000f000
s_mov_b32 s72, 0xcccccccc
s_mov_b32 s73, 0xcccccccc
s_mov_b32 s74, 0x05040100
s_mov_b32 s75, 0x07060302
s_mov_b32 s76, 0xffff0000
s_mov_b32 s77, 0x3fb8aa3b
v_and_b32 v28, 3, v1
v_lshlrev_b32 v29, 8, v28
v_lshrrev_b32 v30, 2, v1
v_lshl_add_u32 v29, v30, 4, v29
s_lshl_b32 s5, s3, 5
v_lshl_add_u32 v28, v28, 3, s5
v_mov_b32 v27, 1792
s_mov_b32 s86, 0x3db504f3
s_mov_b32 s92, 0
s_mov_b64 s[94:95], -1
s_cmp_ge_u32 s3, 99
s_cselect_b32 s88, 4, 3
s_barrier
s_waitcnt vmcnt(1)
buffer_load_dwordx4 v[40:43], v3, s[8:11], s85 offen nt
s_add_u32 s85, s85, s84
s_waitcnt vmcnt(1)
buffer_load_dwordx4 v[44:47], v3, s[8:11], s85 offen nt
s_add_u32 s85, s85, s84
s_waitcnt vmcnt(1)
buffer_load_dwordx4 v[48:51], v3, s[8:11], s85 offen nt
s_add_u32 s85, s85, s84
s_waitcnt vmcnt(1)
buffer_load_dwordx4 v[52:55], v3, s[8:11], s85 offen nt
s_add_u32 s85, s85, s84
s_waitcnt vmcnt(2)
buffer_load_dwordx4 v[56:59], v3, s[8:11], s85 offen nt
s_add_u32 s85, s85, s84
s_waitcnt vmcnt(2)
buffer_load_dwordx4 v[60:63], v3, s[8:11], s85 offen nt
s_add_u32 s85, s85, s84
s_waitcnt vmcnt(2)
buffer_load_dwordx4 v[64:67], v3, s[8:11], s85 offen nt
s_add_u32 s85, s85, s84
s_waitcnt vmcnt(2)
buffer_load_dwordx4 v[68:71], v3, s[8:11], s85 offen nt
s_add_u32 s85, s85, s84
s_waitcnt vmcnt(2)
buffer_load_dwordx4 v[72:75], v3, s[8:11], s85 offen nt
s_add_u32 s85, s85, s84
s_waitcnt vmcnt(2)
buffer_load_dwordx4 v[76:79], v3, s[8:11], s85 offen nt
s_add_u32 s85, s85, s84
s_waitcnt vmcnt(2)
buffer_load_dwordx4 v[80:83], v3, s[8:11], s85 offen nt
s_add_u32 s85, s85, s84
s_waitcnt vmcnt(2)
buffer_load_dwordx4 v[84:87], v3, s[8:11], s85 offen nt
s_add_u32 s85, s85, s84
s_waitcnt vmcnt(2)
buffer_load_dwordx4 v[88:91], v3, s[8:11], s85 offen nt
s_add_u32 s85, s85, s84
s_waitcnt vmcnt(2)
buffer_load_dwordx4 v[92:95], v3, s[8:11], s85 offen nt
s_waitcnt vmcnt(2)
s_mul_i32 s85, s84, 0
s_add_u32 s85, s85, s83
buffer_load_dwordx4 v[96:99], v2, s[12:15], s85 offen nt
s_waitcnt vmcnt(2)
s_mul_i32 s85, s84, 4
s_add_u32 s85, s85, s83
buffer_load_dwordx4 v[100:103], v2, s[12:15], s85 offen nt
s_waitcnt vmcnt(2)
s_mul_i32 s85, s84, 1
s_add_u32 s85, s85, s83
buffer_load_dwordx4 v[104:107], v2, s[12:15], s85 offen nt
s_call_b64 s[90:91], L_att_chk
s_mul_i32 s85, s84, 5
s_add_u32 s85, s85, s83
buffer_load_dwordx4 v[108:111], v2, s[12:15], s85 offen nt
s_call_b64 s[90:91], L_att_chk
s_mul_i32 s85, s84, 2
s_add_u32 s85, s85, s83
buffer_load_dwordx4 v[112:115], v2, s[12:15], s85 offen nt
s_call_b64 s[90:91], L_att_chk
s_mul_i32 s85, s84, 6
s_add_u32 s85, s85, s83
buffer_load_dwordx4 v[116:119], v2, s[12:15], s85 offen nt
s_call_b64 s[90:91], L_att_chk
s_mul_i32 s85, s84, 3
s_add_u32 s85, s85, s83
buffer_load_dwordx4 v[120:123], v2, s[12:15], s85 offen nt
s_call_b64 s[90:91], L_att_chk
s_mul_i32 s85, s84, 7
s_add_u32 s85, s85, s83
buffer_load_dwordx4 v[124:127], v2, s[12:15], s85 offen nt
s_call_b64 s[90:91], L_att_chk
s_mul_i32 s85, s84, 8
s_add_u32 s85, s85, s83
buffer_load_dwordx4 v[128:131], v2, s[12:15], s85 offen nt
s_call_b64 s[90:91], L_att_chk
s_mul_i32 s85, s84, 12
s_add_u32 s85, s85, s83
buffer_load_dwordx4 v[132:135], v2, s[12:15], s85 offen nt
s_call_b64 s[90:91], L_att_chk
s_mul_i32 s85, s84, 9
s_add_u32 s85, s85, s83
buffer_load_dwordx4 v[136:139], v2, s[12:15], s85 offen nt
s_call_b64 s[90:91], L_att_chk
s_mul_i32 s85, s84, 13
s_add_u32 s85, s85, s83
buffer_load_dwordx4 v[140:143], v2, s[12:15], s85 offen nt
s_call_b64 s[90:91], L_att_chk
s_mul_i32 s85, s84, 10
s_add_u32 s85, s85, s83
buffer_load_dwordx4 v[144:147], v2, s[12:15], s85 offen nt
s_call_b64 s[90:91], L_att_chk
s_mul_i32 s85, s84, 14
s_add_u32 s85, s85, s83
buffer_load_dwordx4 v[148:151], v2, s[12:15], s85 offen nt
s_call_b64 s[90:91], L_att_chk
s_mul_i32 s85, s84, 11
s_add_u32 s85, s85, s83
buffer_load_dwordx4 v[152:155], v2, s[12:15], s85 offen nt
s_call_b64 s[90:91], L_att_chk
s_mul_i32 s85, s84, 15
s_add_u32 s85, s85, s83
buffer_load_dwordx4 v[156:159], v2, s[12:15], s85 offen nt
s_cmp_lt_i32 s92, 0
s_cbranch_scc1 L_att_pv
s_mov_b32 s98, 0
LY_1:
ds_read_b32 v26, v27 offset:0
s_waitcnt lgkmcnt(0)
v_readfirstlane_b32 s79, v26
s_nop 0
s_cmp_ge_u32 s79, 1
s_cbranch_scc1 LZ_2
s_sleep 1
s_add_u32 s98, s98, 1
s_cmp_lt_u32 s98, 320000
s_cbranch_scc1 LY_1
LZ_2:
s_call_b64 s[90:91], L_att_qk
L_att_pv:
s_lshl_b32 s5, s3, 11
s_add_u32 s5, s5, 2048
v_add_u32 v3, s5, v2
s_cmp_lg_u32 s3, 0
s_cbranch_scc1 L_att_pv2
s_lshl_b32 s87, s4, 11
s_add_u32 s87, s87, 524288
v_and_b32 v30, 3, v1
v_lshlrev_b32 v30, 9, v30
v_lshrrev_b32 v31, 2, v1
v_lshl_add_u32 v30, v31, 4, v30
v_add_u32 v31, 2048, v2
s_mov_b32 s98, 0
LY_3:
ds_read_b32 v26, v27 offset:8
s_waitcnt lgkmcnt(0)
v_readfirstlane_b32 s79, v26
s_nop 0
s_cmp_ge_u32 s79, 1
s_cbranch_scc1 LZ_4
s_sleep 1
s_add_u32 s98, s98, 1
s_cmp_lt_u32 s98, 320000
s_cbranch_scc1 LY_3
LZ_4:
v_and_b32 v26, 3, v1
v_lshlrev_b32 v26, 2, v26
ds_read_b32 v12, v26 offset:1536
ds_read_b32 v13, v26 offset:1552
ds_read_b32 v14, v26 offset:1568
ds_read_b32 v15, v26 offset:1584
ds_read_b32 v16, v26 offset:1600
ds_read_b32 v17, v26 offset:1616
ds_read_b32 v18, v26 offset:1632
ds_read_b32 v19, v26 offset:1648
ds_read_b32 v20, v26 offset:1664
ds_read_b32 v21, v26 offset:1680
ds_read_b32 v22, v26 offset:1696
s_waitcnt lgkmcnt(0)
L_att_pv2:
s_waitcnt vmcnt(14)
v_perm_b32 v64, v100, v96, s74
v_perm_b32 v65, v100, v96, s75
v_perm_b32 v66, v101, v97, s74
v_perm_b32 v67, v101, v97, s75
v_perm_b32 v68, v102, v98, s74
v_perm_b32 v69, v102, v98, s75
v_mfma_f32_16x16x32_bf16 v[160:163], v[64:67], v[32:35], 0
v_perm_b32 v70, v103, v99, s74
v_perm_b32 v71, v103, v99, s75
s_nop 1
v_mfma_f32_16x16x32_bf16 v[164:167], v[68:71], v[32:35], 0
s_waitcnt vmcnt(12)
v_perm_b32 v72, v108, v104, s74
v_perm_b32 v73, v108, v104, s75
v_perm_b32 v74, v109, v105, s74
v_perm_b32 v75, v109, v105, s75
v_perm_b32 v76, v110, v106, s74
v_perm_b32 v77, v110, v106, s75
v_mfma_f32_16x16x32_bf16 v[160:163], v[72:75], v[36:39], v[160:163]
v_perm_b32 v78, v111, v107, s74
v_perm_b32 v79, v111, v107, s75
s_nop 1
v_mfma_f32_16x16x32_bf16 v[164:167], v[76:79], v[36:39], v[164:167]
s_waitcnt vmcnt(10)
v_perm_b32 v80, v116, v112, s74
v_perm_b32 v81, v116, v112, s75
v_perm_b32 v82, v117, v113, s74
v_perm_b32 v83, v117, v113, s75
v_perm_b32 v84, v118, v114, s74
v_perm_b32 v85, v118, v114, s75
v_mfma_f32_16x16x32_bf16 v[160:163], v[80:83], v[40:43], v[160:163]
v_perm_b32 v86, v119, v115, s74
v_perm_b32 v87, v119, v115, s75
s_nop 1
v_mfma_f32_16x16x32_bf16 v[164:167], v[84:87], v[40:43], v[164:167]
s_waitcnt vmcnt(8)
v_perm_b32 v88, v124, v120, s74
v_perm_b32 v89, v124, v120, s75
v_perm_b32 v90, v125, v121, s74
v_perm_b32 v91, v125, v121, s75
v_perm_b32 v92, v126, v122, s74
v_perm_b32 v93, v126, v122, s75
v_mfma_f32_16x16x32_bf16 v[160:163], v[88:91], v[44:47], v[160:163]
v_perm_b32 v94, v127, v123, s74
v_perm_b32 v95, v127, v123, s75
s_nop 1
v_mfma_f32_16x16x32_bf16 v[164:167], v[92:95], v[44:47], v[164:167]
s_waitcnt vmcnt(6)
v_perm_b32 v64, v132, v128, s74
v_perm_b32 v65, v132, v128, s75
v_perm_b32 v66, v133, v129, s74
v_perm_b32 v67, v133, v129, s75
v_perm_b32 v68, v134, v130, s74
v_perm_b32 v69, v134, v130, s75
v_mfma_f32_16x16x32_bf16 v[160:163], v[64:67], v[48:51], v[160:163]
v_perm_b32 v70, v135, v131, s74
v_perm_b32 v71, v135, v131, s75
s_nop 1
v_mfma_f32_16x16x32_bf16 v[164:167], v[68:71], v[48:51], v[164:167]
s_waitcnt vmcnt(4)
v_perm_b32 v72, v140, v136, s74
v_perm_b32 v73, v140, v136, s75
v_perm_b32 v74, v141, v137, s74
v_perm_b32 v75, v141, v137, s75
v_perm_b32 v76, v142, v138, s74
v_perm_b32 v77, v142, v138, s75
v_mfma_f32_16x16x32_bf16 v[160:163], v[72:75], v[52:55], v[160:163]
v_perm_b32 v78, v143, v139, s74
v_perm_b32 v79, v143, v139, s75
s_nop 1
v_mfma_f32_16x16x32_bf16 v[164:167], v[76:79], v[52:55], v[164:167]
s_waitcnt vmcnt(2)
v_perm_b32 v80, v148, v144, s74
v_perm_b32 v81, v148, v144, s75
v_perm_b32 v82, v149, v145, s74
v_perm_b32 v83, v149, v145, s75
v_perm_b32 v84, v150, v146, s74
v_perm_b32 v85, v150, v146, s75
v_mfma_f32_16x16x32_bf16 v[160:163], v[80:83], v[56:59], v[160:163]
v_perm_b32 v86, v151, v147, s74
v_perm_b32 v87, v151, v147, s75
s_nop 1
v_mfma_f32_16x16x32_bf16 v[164:167], v[84:87], v[56:59], v[164:167]
s_waitcnt vmcnt(0)
v_perm_b32 v88, v156, v152, s74
v_perm_b32 v89, v156, v152, s75
v_perm_b32 v90, v157, v153, s74
v_perm_b32 v91, v157, v153, s75
v_perm_b32 v92, v158, v154, s74
v_perm_b32 v93, v158, v154, s75
v_mfma_f32_16x16x32_bf16 v[160:163], v[88:91], v[60:63], v[160:163]
v_perm_b32 v94, v159, v155, s74
v_perm_b32 v95, v159, v155, s75
s_nop 1
v_mfma_f32_16x16x32_bf16 v[164:167], v[92:95], v[60:63], v[164:167]
s_nop 2
ds_write_b128 v3, v[160:163]
s_nop 3
ds_write_b128 v3, v[164:167] offset:1024
s_waitcnt lgkmcnt(0)
s_cbranch_execz L_att_red
s_cmp_eq_u32 s3, 0
s_cbranch_scc1 L_att_red
s_barrier
s_endpgm
L_att_chk:
s_cmp_lt_i32 s92, 0
s_cbranch_scc1 L_att_w2
s_cmp_gt_i32 s92, 0
s_cbranch_scc1 L_att_cd
s_mov_b32 s93, 0
L_att_sp:
ds_read_b32 v26, v27
s_waitcnt lgkmcnt(0)
v_readfirstlane_b32 s5, v26
s_nop 0
s_cmp_lg_u32 s5, 0
s_cbranch_scc1 L_att_fl
s_getreg_b32 s5, hwreg(HW_REG_IB_STS, 0, 4)
s_cmp_lt_u32 s5, s88
s_cbranch_scc1 L_att_wt
s_add_u32 s93, s93, 1
s_cmp_lt_u32 s93, 24
s_cbranch_scc1 L_att_sp
L_att_wt:
s_waitcnt vmcnt(2)
s_setpc_b64 s[90:91]
L_att_w2:
s_waitcnt vmcnt(3)
s_setpc_b64 s[90:91]
L_att_fl:
s_lshr_b32 s92, s3, 2
s_mul_i32 s92, s92, 2
s_lshr_b32 s92, s92, 1
s_add_u32 s92, s92, 1
L_att_cd:
s_sub_u32 s92, s92, 1
s_cmp_eq_u32 s92, 0
s_cbranch_scc1 L_att_qk
s_setpc_b64 s[90:91]
L_att_qk:
ds_read_b128 v[4:7], v29 offset:0
s_mov_b32 s92, -1
s_waitcnt lgkmcnt(0)
v_mfma_f32_16x16x32_bf16 v[12:15], v[32:35], v[4:7], 0
v_mfma_f32_16x16x32_bf16 v[16:19], v[36:39], v[4:7], 0
v_mfma_f32_16x16x32_bf16 v[20:23], v[40:43], v[4:7], 0
v_mfma_f32_16x16x32_bf16 v[32:35], v[44:47], v[4:7], 0
v_mfma_f32_16x16x32_bf16 v[36:39], v[48:51], v[4:7], 0
s_nop 3
v_add_f32_dpp v12, v13, v12 row_ror:12 row_mask:0xf bank_mask:0xf
v_add_f32_dpp v14, v15, v14 row_ror:12 row_mask:0xf bank_mask:0xf
v_mfma_f32_16x16x32_bf16 v[40:43], v[52:55], v[4:7], 0
v_add_f32_dpp v17, v18, v17 row_ror:12 row_mask:0xf bank_mask:0xf
v_add_f32_dpp v19, v16, v19 row_ror:12 row_mask:0xf bank_mask:0xf
v_add_f32_dpp v8, v14, v12 row_ror:8 row_mask:0xf bank_mask:0x1
v_mfma_f32_16x16x32_bf16 v[44:47], v[56:59], v[4:7], 0
v_add_f32_dpp v22, v23, v22 row_ror:12 row_mask:0xf bank_mask:0xf
v_add_f32_dpp v20, v21, v20 row_ror:12 row_mask:0xf bank_mask:0xf
v_add_f32_dpp v8, v19, v17 row_ror:8 row_mask:0xf bank_mask:0x2
v_mfma_f32_16x16x32_bf16 v[48:51], v[60:63], v[4:7], 0
v_add_f32_dpp v35, v32, v35 row_ror:12 row_mask:0xf bank_mask:0xf
v_add_f32_dpp v33, v34, v33 row_ror:12 row_mask:0xf bank_mask:0xf
v_add_f32_dpp v8, v20, v22 row_ror:8 row_mask:0xf bank_mask:0x4
v_mfma_f32_16x16x32_bf16 v[52:55], v[64:67], v[4:7], 0
v_add_f32_dpp v36, v37, v36 row_ror:12 row_mask:0xf bank_mask:0xf
v_add_f32_dpp v38, v39, v38 row_ror:12 row_mask:0xf bank_mask:0xf
v_add_f32_dpp v8, v33, v35 row_ror:8 row_mask:0xf bank_mask:0x8
v_mfma_f32_16x16x32_bf16 v[56:59], v[68:71], v[4:7], 0
v_add_f32_dpp v41, v42, v41 row_ror:12 row_mask:0xf bank_mask:0xf
v_add_f32_dpp v43, v40, v43 row_ror:12 row_mask:0xf bank_mask:0xf
v_add_f32_dpp v9, v38, v36 row_ror:8 row_mask:0xf bank_mask:0x1
v_mfma_f32_16x16x32_bf16 v[60:63], v[72:75], v[4:7], 0
v_add_f32_dpp v46, v47, v46 row_ror:12 row_mask:0xf bank_mask:0xf
v_add_f32_dpp v44, v45, v44 row_ror:12 row_mask:0xf bank_mask:0xf
v_add_f32_dpp v9, v43, v41 row_ror:8 row_mask:0xf bank_mask:0x2
v_mfma_f32_16x16x32_bf16 v[64:67], v[76:79], v[4:7], 0
v_add_f32_dpp v51, v48, v51 row_ror:12 row_mask:0xf bank_mask:0xf
v_add_f32_dpp v49, v50, v49 row_ror:12 row_mask:0xf bank_mask:0xf
v_add_f32_dpp v9, v44, v46 row_ror:8 row_mask:0xf bank_mask:0x4
v_mfma_f32_16x16x32_bf16 v[68:71], v[80:83], v[4:7], 0
v_add_f32_dpp v52, v53, v52 row_ror:12 row_mask:0xf bank_mask:0xf
v_add_f32_dpp v54, v55, v54 row_ror:12 row_mask:0xf bank_mask:0xf
v_add_f32_dpp v9, v49, v51 row_ror:8 row_mask:0xf bank_mask:0x8
v_mfma_f32_16x16x32_bf16 v[72:75], v[84:87], v[4:7], 0
v_add_f32_dpp v57, v58, v57 row_ror:12 row_mask:0xf bank_mask:0xf
v_add_f32_dpp v59, v56, v59 row_ror:12 row_mask:0xf bank_mask:0xf
v_add_f32_dpp v10, v54, v52 row_ror:8 row_mask:0xf bank_mask:0x1
v_mfma_f32_16x16x32_bf16 v[76:79], v[88:91], v[4:7], 0
v_add_f32_dpp v62, v63, v62 row_ror:12 row_mask:0xf bank_mask:0xf
v_add_f32_dpp v60, v61, v60 row_ror:12 row_mask:0xf bank_mask:0xf
v_add_f32_dpp v10, v59, v57 row_ror:8 row_mask:0xf bank_mask:0x2
v_mfma_f32_16x16x32_bf16 v[80:83], v[92:95], v[4:7], 0
v_add_f32_dpp v67, v64, v67 row_ror:12 row_mask:0xf bank_mask:0xf
v_add_f32_dpp v65, v66, v65 row_ror:12 row_mask:0xf bank_mask:0xf
v_add_f32_dpp v10, v60, v62 row_ror:8 row_mask:0xf bank_mask:0x4
v_add_f32_dpp v68, v69, v68 row_ror:12 row_mask:0xf bank_mask:0xf
v_add_f32_dpp v70, v71, v70 row_ror:12 row_mask:0xf bank_mask:0xf
v_add_f32_dpp v10, v65, v67 row_ror:8 row_mask:0xf bank_mask:0x8
v_add_f32_dpp v73, v74, v73 row_ror:12 row_mask:0xf bank_mask:0xf
v_add_f32_dpp v75, v72, v75 row_ror:12 row_mask:0xf bank_mask:0xf
v_add_f32_dpp v11, v70, v68 row_ror:8 row_mask:0xf bank_mask:0x1
v_add_f32_dpp v78, v79, v78 row_ror:12 row_mask:0xf bank_mask:0xf
v_add_f32_dpp v76, v77, v76 row_ror:12 row_mask:0xf bank_mask:0xf
v_add_f32_dpp v11, v75, v73 row_ror:8 row_mask:0xf bank_mask:0x2
v_add_f32_dpp v83, v80, v83 row_ror:12 row_mask:0xf bank_mask:0xf
v_add_f32_dpp v81, v82, v81 row_ror:12 row_mask:0xf bank_mask:0xf
v_add_f32_dpp v11, v76, v78 row_ror:8 row_mask:0xf bank_mask:0x4
s_nop 1
v_add_f32_dpp v11, v81, v83 row_ror:8 row_mask:0xf bank_mask:0x8
v_cvt_pk_bf16_f32 v12, v8, v9
v_cvt_pk_bf16_f32 v13, v10, v11
v_lshlrev_b32 v8, 16, v12
v_and_b32 v9, s76, v12
v_lshlrev_b32 v10, 16, v13
v_and_b32 v11, s76, v13
v_mul_f32 v8, s86, v8
v_mul_f32 v9, s86, v9
v_mul_f32 v10, s86, v10
v_mul_f32 v11, s86, v11
v_cvt_pk_bf16_f32 v12, v8, v9
v_cvt_pk_bf16_f32 v13, v10, v11
v_lshlrev_b32 v8, 16, v12
v_and_b32 v9, s76, v12
v_lshlrev_b32 v10, 16, v13
v_and_b32 v11, s76, v13
v_max3_f32 v12, v8, v9, v10
v_max_f32 v12, v12, v11
s_nop 1
v_max_f32_dpp v12, v12, v12 row_ror:4 row_mask:0xf bank_mask:0xf
s_nop 1
v_max_f32_dpp v12, v12, v12 row_ror:8 row_mask:0xf bank_mask:0xf
v_mov_b32 v13, v12
s_nop 1
v_permlane16_swap_b32 v12, v13
v_max_f32 v12, v12, v13
v_mov_b32 v13, v12
s_nop 1
v_permlane32_swap_b32 v12, v13
v_max_f32 v12, v12, v13
v_mul_f32 v14, s77, v12
v_fma_f32 v8, v8, s77, -v14
v_fma_f32 v9, v9, s77, -v14
v_fma_f32 v10, v10, s77, -v14
v_fma_f32 v11, v11, s77, -v14
v_exp_f32 v8, v8
v_exp_f32 v9, v9
v_exp_f32 v10, v10
v_exp_f32 v11, v11
v_cndmask_b32 v20, 0, -1, s[64:65]
v_cndmask_b32 v21, 0, -1, s[66:67]
v_cndmask_b32 v22, 0, -1, s[68:69]
v_cndmask_b32 v23, 0, -1, s[70:71]
v_cvt_pk_bf16_f32 v16, v8, v9
v_add_f32 v13, v8, v9
v_cvt_pk_bf16_f32 v17, v10, v11
v_add_f32 v18, v10, v11
v_and_b32_dpp v32, v16, v20 quad_perm:[0,1,2,3] row_mask:0xf bank_mask:0xf
v_and_b32_dpp v36, v16, v20 row_ror:12 row_mask:0xf bank_mask:0xf
v_and_b32_dpp v40, v16, v20 row_ror:8 row_mask:0xf bank_mask:0xf
v_add_f32 v13, v13, v18
v_and_b32_dpp v44, v16, v20 row_ror:4 row_mask:0xf bank_mask:0xf
v_and_b32_dpp v48, v17, v20 quad_perm:[0,1,2,3] row_mask:0xf bank_mask:0xf
v_and_b32_dpp v52, v17, v20 row_ror:12 row_mask:0xf bank_mask:0xf
v_add_f32_dpp v13, v13, v13 row_ror:4 row_mask:0xf bank_mask:0xf
v_and_b32_dpp v56, v17, v20 row_ror:8 row_mask:0xf bank_mask:0xf
v_and_b32_dpp v60, v17, v20 row_ror:4 row_mask:0xf bank_mask:0xf
v_and_b32_dpp v33, v16, v21 row_ror:4 row_mask:0xf bank_mask:0xf
v_add_f32_dpp v13, v13, v13 row_ror:8 row_mask:0xf bank_mask:0xf
v_and_b32_dpp v37, v16, v21 quad_perm:[0,1,2,3] row_mask:0xf bank_mask:0xf
v_and_b32_dpp v41, v16, v21 row_ror:12 row_mask:0xf bank_mask:0xf
v_and_b32_dpp v45, v16, v21 row_ror:8 row_mask:0xf bank_mask:0xf
v_mov_b32 v18, v13
v_and_b32_dpp v49, v17, v21 row_ror:4 row_mask:0xf bank_mask:0xf
v_and_b32_dpp v53, v17, v21 quad_perm:[0,1,2,3] row_mask:0xf bank_mask:0xf
v_and_b32_dpp v57, v17, v21 row_ror:12 row_mask:0xf bank_mask:0xf
v_permlane16_swap_b32 v13, v18
v_and_b32_dpp v61, v17, v21 row_ror:8 row_mask:0xf bank_mask:0xf
v_and_b32_dpp v34, v16, v22 row_ror:8 row_mask:0xf bank_mask:0xf
v_and_b32_dpp v38, v16, v22 row_ror:4 row_mask:0xf bank_mask:0xf
v_add_f32 v13, v13, v18
v_and_b32_dpp v42, v16, v22 quad_perm:[0,1,2,3] row_mask:0xf bank_mask:0xf
v_and_b32_dpp v46, v16, v22 row_ror:12 row_mask:0xf bank_mask:0xf
v_and_b32_dpp v50, v17, v22 row_ror:8 row_mask:0xf bank_mask:0xf
v_mov_b32 v18, v13
v_and_b32_dpp v54, v17, v22 row_ror:4 row_mask:0xf bank_mask:0xf
v_and_b32_dpp v58, v17, v22 quad_perm:[0,1,2,3] row_mask:0xf bank_mask:0xf
v_and_b32_dpp v62, v17, v22 row_ror:12 row_mask:0xf bank_mask:0xf
v_permlane32_swap_b32 v13, v18
v_and_b32_dpp v35, v16, v23 row_ror:12 row_mask:0xf bank_mask:0xf
v_and_b32_dpp v39, v16, v23 row_ror:8 row_mask:0xf bank_mask:0xf
v_and_b32_dpp v43, v16, v23 row_ror:4 row_mask:0xf bank_mask:0xf
v_add_f32 v13, v13, v18
v_and_b32_dpp v47, v16, v23 quad_perm:[0,1,2,3] row_mask:0xf bank_mask:0xf
v_and_b32_dpp v51, v17, v23 row_ror:12 row_mask:0xf bank_mask:0xf
v_and_b32_dpp v55, v17, v23 row_ror:8 row_mask:0xf bank_mask:0xf
v_mov_b32 v14, 1
v_and_b32_dpp v59, v17, v23 row_ror:4 row_mask:0xf bank_mask:0xf
v_and_b32_dpp v63, v17, v23 quad_perm:[0,1,2,3] row_mask:0xf bank_mask:0xf
s_and_b32 exec_lo, 0xf, s94
s_and_b32 exec_hi, 0x0, s95
ds_write_b64 v28, v[12:13] offset:1024
s_and_b32 exec_lo, 0x1, s94
s_and_b32 exec_hi, 0x0, s95
ds_add_u32 v27, v14 offset:4
s_mov_b64 exec, s[94:95]
s_setpc_b64 s[90:91]
L_att_ctl:
s_setprio 3
v_lshlrev_b32 v2, 4, v1
v_mov_b32 v16, 0xff800000
v_mov_b32 v17, 0
v_lshlrev_b32 v6, 3, v1
ds_write_b64 v6, v[16:17] offset:1024
v_mov_b32 v8, -1
v_mov_b32 v12, 0
v_mov_b32 v9, -1
v_mov_b32 v13, 0
v_mov_b32 v10, -1
v_mov_b32 v14, 0
v_mov_b32 v11, -1
v_mov_b32 v15, 0
v_mov_b32 v27, 1792
ds_write_b128 v27, v[12:15]
ds_write_b128 v2, v[12:15] offset:22528
ds_write_b128 v2, v[12:15] offset:23552
s_waitcnt lgkmcnt(0)
s_barrier
s_load_dword s96, s[16:17], 0x0
s_lshl_b32 s87, s4, 11
s_add_u32 s87, s87, 524288
v_and_b32 v30, 3, v1
v_lshlrev_b32 v30, 9, v30
v_lshrrev_b32 v31, 2, v1
v_lshl_add_u32 v30, v31, 4, v30
v_add_u32 v30, 256, v30
v_add_u32 v31, 3072, v2
s_and_b32 s84, s80, 7
s_lshl_b32 s84, s84, 2
s_mul_i32 s84, s84, 14976
s_add_u32 s84, s84, 32768
s_lshr_b32 s85, s80, 3
buffer_store_dwordx4 v[8:11], v2, s[16:19], s87 offen sc1
buffer_store_dwordx4 v[8:11], v2, s[16:19], s87 offen offset:1024 sc1
s_lshl_b32 s93, s4, 7
s_add_u32 s93, s93, 917504
s_mov_b64 exec, 3
buffer_store_dwordx4 v[8:11], v2, s[16:19], s93 offen sc1
s_mov_b64 exec, -1
s_mov_b64 s[94:95], -1
v_mov_b32 v12, 0
v_lshlrev_b32 v6, 3, v1
v_mov_b32 v27, 1792
v_lshrrev_b32 v7, 5, v1
v_mul_u32_u24 v24, 14976, v7
v_and_b32 v16, 31, v1
v_lshl_add_u32 v24, v16, 4, v24
v_lshlrev_b32 v25, 8, v7
v_lshl_add_u32 v25, v16, 3, v25
s_lshl_b32 s5, s85, 9
s_add_u32 s86, s84, s5
s_add_u32 s86, s86, 9216
s_add_u32 s83, s86, 29952
s_mov_b32 s77, 0x3fb8aa3b
s_waitcnt lgkmcnt(0)
s_mul_i32 s97, s96, 0x9e3779b1
s_add_u32 s97, s97, 0x85ebca6b
s_mov_b32 s98, 0
LU_5:
buffer_load_dwordx4 v[80:83], v24, s[16:19], s86 offen sc1
buffer_load_dwordx4 v[84:87], v24, s[16:19], s83 offen sc1
s_waitcnt vmcnt(0)
v_cmp_ne_u32 vcc, s97, v81
v_cmp_ne_u32 s[88:89], s97, v83
s_nop 0
s_or_b64 vcc, vcc, s[88:89]
v_cmp_ne_u32 s[88:89], s97, v85
s_nop 0
s_or_b64 vcc, vcc, s[88:89]
v_cmp_ne_u32 s[88:89], s97, v87
s_nop 0
s_or_b64 vcc, vcc, s[88:89]
s_cmp_eq_u64 vcc, 0
s_cbranch_scc1 LO_7
s_add_u32 s98, s98, 1
s_cmp_lt_u32 s98, 40000
s_cbranch_scc1 LU_5
LO_7:
v_mov_b32 v16, v80
v_mov_b32 v17, v82
v_mov_b32 v18, v84
v_mov_b32 v19, v86
LV_6:
v_mov_b32 v26, 1
ds_write_b64 v25, v[16:17] offset:0
ds_write_b64 v25, v[18:19] offset:512
ds_write_b32 v27, v26
s_mov_b64 exec, 1
s_mov_b32 s98, 0
LP_8:
buffer_load_dword v16, v12, s[20:23], 0 offen offset:128 sc1
s_waitcnt vmcnt(0)
v_cmp_eq_u32 vcc, 0, v16
s_cbranch_vccz LD_9
s_sleep 2
s_add_u32 s98, s98, 1
s_cmp_lt_u32 s98, 40000
s_cbranch_scc1 LP_8
LD_9:
s_mov_b64 exec, -1
v_and_b32 v3, 3, v1
v_mul_u32_u24 v7, 14976, v3
s_mul_i32 s5, s85, 12
s_add_u32 s5, s5, s81
s_lshl_b32 s5, s5, 3
s_add_u32 s5, s5, s84
s_add_u32 s86, s5, 10368
v_mov_b32 v13, 0
s_mov_b64 exec, 0xf
buffer_store_dwordx2 v[12:13], v7, s[16:19], s86 offen sc1
s_mov_b64 exec, -1
v_lshlrev_b32 v7, 3, v3
s_mov_b32 s98, 0
LY_11:
ds_read_b32 v26, v27 offset:4
s_waitcnt lgkmcnt(0)
v_readfirstlane_b32 s79, v26
s_nop 0
s_cmp_ge_u32 s79, s82
s_cbranch_scc1 LZ_12
s_sleep 1
s_add_u32 s98, s98, 1
s_cmp_lt_u32 s98, 320000
s_cbranch_scc1 LY_11
LZ_12:
ds_read_b64 v[18:19], v6 offset:1024
s_waitcnt lgkmcnt(0)
v_max_f32_dpp v16, v18, v18 row_ror:4 row_mask:0xf bank_mask:0xf
s_nop 1
v_max_f32_dpp v16, v16, v16 row_ror:8 row_mask:0xf bank_mask:0xf
v_mov_b32 v17, v16
s_nop 1
v_permlane16_swap_b32 v16, v17
v_max_f32 v16, v16, v17
v_mov_b32 v17, v16
s_nop 1
v_permlane32_swap_b32 v16, v17
v_max_f32 v16, v16, v17
v_sub_f32 v18, v18, v16
v_mul_f32 v18, s77, v18
v_exp_f32 v18, v18
v_lshlrev_b32 v6, 2, v1
v_mul_f32 v17, v18, v19
ds_write_b32 v6, v18 offset:1536
v_mov_b32 v26, 1
ds_write_b32 v27, v26 offset:8
v_add_f32_dpp v17, v17, v17 row_ror:4 row_mask:0xf bank_mask:0xf
s_nop 1
v_add_f32_dpp v17, v17, v17 row_ror:8 row_mask:0xf bank_mask:0xf
v_mov_b32 v18, v17
s_nop 1
v_permlane16_swap_b32 v17, v18
v_add_f32 v17, v17, v18
v_mov_b32 v18, v17
s_nop 1
v_permlane32_swap_b32 v17, v18
v_add_f32 v17, v17, v18
s_mov_b64 exec, 0xf
buffer_store_dwordx2 v[16:17], v7, s[16:19], s93 offen sc1
s_mov_b64 exec, -1
s_mov_b32 s98, 0
LY_13:
ds_read_b32 v26, v27 offset:8
s_waitcnt lgkmcnt(0)
v_readfirstlane_b32 s79, v26
s_nop 0
s_cmp_ge_u32 s79, 1
s_cbranch_scc1 LZ_14
s_sleep 1
s_add_u32 s98, s98, 1
s_cmp_lt_u32 s98, 320000
s_cbranch_scc1 LY_13
LZ_14:
v_and_b32 v26, 3, v1
v_lshlrev_b32 v26, 2, v26
ds_read_b32 v12, v26 offset:1536
ds_read_b32 v13, v26 offset:1552
ds_read_b32 v14, v26 offset:1568
ds_read_b32 v15, v26 offset:1584
ds_read_b32 v16, v26 offset:1600
ds_read_b32 v17, v26 offset:1616
ds_read_b32 v18, v26 offset:1632
ds_read_b32 v19, v26 offset:1648
ds_read_b32 v20, v26 offset:1664
ds_read_b32 v21, v26 offset:1680
ds_read_b32 v22, v26 offset:1696
s_waitcnt lgkmcnt(0)
L_att_red:
s_barrier
ds_read_b128 v[32:35], v31 offset:0
ds_read_b128 v[36:39], v31 offset:2048
ds_read_b128 v[40:43], v31 offset:4096
ds_read_b128 v[44:47], v31 offset:6144
ds_read_b128 v[48:51], v31 offset:8192
ds_read_b128 v[52:55], v31 offset:10240
ds_read_b128 v[56:59], v31 offset:12288
ds_read_b128 v[60:63], v31 offset:14336
ds_read_b128 v[64:67], v31 offset:16384
ds_read_b128 v[68:71], v31 offset:18432
ds_read_b128 v[72:75], v31 offset:20480
s_waitcnt lgkmcnt(10)
v_pk_mul_f32 v[32:33], v[32:33], v[12:13] op_sel_hi:[1,0]
v_pk_mul_f32 v[34:35], v[34:35], v[12:13] op_sel_hi:[1,0]
s_waitcnt lgkmcnt(9)
v_pk_fma_f32 v[32:33], v[36:37], v[12:13], v[32:33] op_sel:[0,1,0] op_sel_hi:[1,1,1]
v_pk_fma_f32 v[34:35], v[38:39], v[12:13], v[34:35] op_sel:[0,1,0] op_sel_hi:[1,1,1]
s_waitcnt lgkmcnt(8)
v_pk_fma_f32 v[32:33], v[40:41], v[14:15], v[32:33] op_sel_hi:[1,0,1]
v_pk_fma_f32 v[34:35], v[42:43], v[14:15], v[34:35] op_sel_hi:[1,0,1]
s_waitcnt lgkmcnt(7)
v_pk_fma_f32 v[32:33], v[44:45], v[14:15], v[32:33] op_sel:[0,1,0] op_sel_hi:[1,1,1]
v_pk_fma_f32 v[34:35], v[46:47], v[14:15], v[34:35] op_sel:[0,1,0] op_sel_hi:[1,1,1]
s_waitcnt lgkmcnt(6)
v_pk_fma_f32 v[32:33], v[48:49], v[16:17], v[32:33] op_sel_hi:[1,0,1]
v_pk_fma_f32 v[34:35], v[50:51], v[16:17], v[34:35] op_sel_hi:[1,0,1]
s_waitcnt lgkmcnt(5)
v_pk_fma_f32 v[32:33], v[52:53], v[16:17], v[32:33] op_sel:[0,1,0] op_sel_hi:[1,1,1]
v_pk_fma_f32 v[34:35], v[54:55], v[16:17], v[34:35] op_sel:[0,1,0] op_sel_hi:[1,1,1]
s_waitcnt lgkmcnt(4)
v_pk_fma_f32 v[32:33], v[56:57], v[18:19], v[32:33] op_sel_hi:[1,0,1]
v_pk_fma_f32 v[34:35], v[58:59], v[18:19], v[34:35] op_sel_hi:[1,0,1]
s_waitcnt lgkmcnt(3)
v_pk_fma_f32 v[32:33], v[60:61], v[18:19], v[32:33] op_sel:[0,1,0] op_sel_hi:[1,1,1]
v_pk_fma_f32 v[34:35], v[62:63], v[18:19], v[34:35] op_sel:[0,1,0] op_sel_hi:[1,1,1]
s_waitcnt lgkmcnt(2)
v_pk_fma_f32 v[32:33], v[64:65], v[20:21], v[32:33] op_sel_hi:[1,0,1]
v_pk_fma_f32 v[34:35], v[66:67], v[20:21], v[34:35] op_sel_hi:[1,0,1]
s_waitcnt lgkmcnt(1)
v_pk_fma_f32 v[32:33], v[68:69], v[20:21], v[32:33] op_sel:[0,1,0] op_sel_hi:[1,1,1]
v_pk_fma_f32 v[34:35], v[70:71], v[20:21], v[34:35] op_sel:[0,1,0] op_sel_hi:[1,1,1]
s_waitcnt lgkmcnt(0)
v_pk_fma_f32 v[32:33], v[72:73], v[22:23], v[32:33] op_sel_hi:[1,0,1]
v_pk_fma_f32 v[34:35], v[74:75], v[22:23], v[34:35] op_sel_hi:[1,0,1]
buffer_store_dwordx4 v[32:35], v30, s[16:19], s87 offen sc1
s_endpgm
L_head:
s_mul_i32 s80, s4, 14976
s_add_u32 s80, s80, 32768
v_lshlrev_b32 v2, 4, v1
s_mov_b32 s58, 0x300000
s_mov_b32 s59, 0x20000
s_mov_b32 s54, 0x800
s_mov_b32 s55, 0x20000
s_mov_b32 s64, 0xf000f
s_mov_b32 s65, 0xf000f
s_mov_b32 s66, 0xf000f0
s_mov_b32 s67, 0xf000f0
s_mov_b32 s68, 0xf000f00
s_mov_b32 s69, 0xf000f00
s_mov_b32 s70, 0xf000f000
s_mov_b32 s71, 0xf000f000
s_mov_b32 s72, 0xcccccccc
s_mov_b32 s73, 0xcccccccc
s_mov_b32 s74, 0x05040100
s_mov_b32 s75, 0x07060302
s_mov_b32 s76, 0xffff0000
s_mov_b32 s77, 0x3fb8aa3b
v_lshrrev_b32 v5, 4, v1
v_mul_u32_u24 v5, 49152, v5
v_and_b32 v4, 15, v1
v_lshl_add_u32 v5, v4, 4, v5
v_and_b32 v6, 1, v1
v_mul_u32_u24 v6, 1024, v6
v_lshrrev_b32 v4, 4, v1
v_lshl_add_u32 v6, v4, 4, v6
s_and_b32 s5, s4, 1
s_lshl_b32 s5, s5, 8
s_lshl_b32 s6, s3, 6
s_add_u32 s85, s5, s6
s_mul_i32 s5, s85, 6144
s_lshr_b32 s6, s4, 1
s_lshl_b32 s6, s6, 8
s_add_u32 s86, s5, s6
s_add_u32 s86, s86, 2048
s_lshl_b32 s85, s85, 1
v_mov_b32 v8, -1
v_mov_b32 v9, -1
v_mov_b32 v10, -1
v_mov_b32 v11, -1
s_add_u32 s5, s80, 8192
s_waitcnt lgkmcnt(0)
s_cmp_lg_u32 s3, 0
s_cbranch_scc1 L_h_nc
buffer_store_dwordx4 v[8:11], v2, s[16:19], s5 offen sc1
s_load_dword s96, s[16:17], 0x0
L_h_nc:
buffer_load_dwordx4 v[160:163], v6, s[52:55], s85 offen
buffer_load_dwordx4 v[164:167], v6, s[52:55], s85 offen offset:64
s_cmp_lg_u32 s3, 3
s_cbranch_scc1 L_h_ni
v_mov_b32 v8, 0
v_lshlrev_b32 v9, 2, v1
v_add_u32 v10, 100000, v9
ds_write_b32 v10, v8
v_add_u32 v10, 101376, v9
s_mov_b64 exec, 0xffff
ds_write_b32 v10, v8
s_mov_b64 exec, -1
s_waitcnt lgkmcnt(0)
L_h_ni:
s_barrier
s_cmp_lg_u32 s3, 0
s_cbranch_scc1 L_h_wh
v_mov_b32 v12, 1
v_mov_b32 v13, 0
v_lshrrev_b32 v3, 3, v1
v_mul_u32_u24 v4, 14976, v3
v_and_b32 v7, 7, v1
v_lshl_add_u32 v4, v7, 4, v4
v_lshlrev_b32 v3, 5, v3
v_bfe_u32 v7, v1, 2, 1
v_mul_u32_u24 v7, 1088, v7
v_add_u32 v3, v3, v7
v_and_b32 v7, 3, v1
v_lshl_add_u32 v3, v7, 3, v3
v_add_u32 v3, 65536, v3
s_waitcnt lgkmcnt(0)
s_mul_i32 s97, s96, 0x9e3779b1
s_add_u32 s97, s97, 0x85ebca6b
s_waitcnt vmcnt(2)
s_mov_b64 exec, 1
buffer_atomic_add v12, v13, s[20:23], 0 offen sc1
s_mov_b64 exec, -1
s_mov_b32 s81, 43392
s_mov_b32 s82, 163200
s_mov_b32 s83, 283008
s_mov_b32 s84, 402816
s_mov_b32 s98, 0
LU_15:
buffer_load_dwordx4 v[32:35], v4, s[16:19], s81 offen sc1
buffer_load_dwordx4 v[36:39], v4, s[16:19], s82 offen sc1
buffer_load_dwordx4 v[40:43], v4, s[16:19], s83 offen sc1
buffer_load_dwordx4 v[44:47], v4, s[16:19], s84 offen sc1
s_waitcnt vmcnt(0)
v_cmp_ne_u32 vcc, s97, v33
v_cmp_ne_u32 s[88:89], s97, v35
s_nop 0
s_or_b64 vcc, vcc, s[88:89]
v_cmp_ne_u32 s[88:89], s97, v37
s_nop 0
s_or_b64 vcc, vcc, s[88:89]
v_cmp_ne_u32 s[88:89], s97, v39
s_nop 0
s_or_b64 vcc, vcc, s[88:89]
v_cmp_ne_u32 s[88:89], s97, v41
s_nop 0
s_or_b64 vcc, vcc, s[88:89]
v_cmp_ne_u32 s[88:89], s97, v43
s_nop 0
s_or_b64 vcc, vcc, s[88:89]
v_cmp_ne_u32 s[88:89], s97, v45
s_nop 0
s_or_b64 vcc, vcc, s[88:89]
v_cmp_ne_u32 s[88:89], s97, v47
s_nop 0
s_or_b64 vcc, vcc, s[88:89]
s_cmp_eq_u64 vcc, 0
s_cbranch_scc1 LO_17
s_sleep 1
s_add_u32 s98, s98, 1
s_cmp_lt_u32 s98, 40000
s_cbranch_scc1 LU_15
LO_17:
v_mov_b32 v16, v32
v_mov_b32 v17, v34
v_mov_b32 v18, v36
v_mov_b32 v19, v38
v_mov_b32 v20, v40
v_mov_b32 v21, v42
v_mov_b32 v22, v44
v_mov_b32 v23, v46
LV_16:
ds_write_b64 v3, v[16:17] offset:0
ds_write_b64 v3, v[18:19] offset:256
ds_write_b64 v3, v[20:21] offset:512
ds_write_b64 v3, v[22:23] offset:768
v_mov_b32 v8, 101392
v_mov_b32 v9, 1
s_mov_b64 exec, 1
ds_add_u32 v8, v9
s_mov_b64 exec, -1
L_h_wh:
s_waitcnt vmcnt(0)
s_mov_b32 s99, 0x7e800000
v_lshlrev_b32 v8, 16, v160
v_and_b32 v9, s76, v160
v_mul_f32 v10, s77, v8
v_mul_f32 v11, s77, v9
v_exp_f32 v10, -v10
v_exp_f32 v11, -v11
v_add_f32 v10, 1.0, v10
v_add_f32 v11, 1.0, v11
v_rcp_f32 v12, v10
v_rcp_f32 v13, v11
v_mul_f32 v14, v8, v12
v_mul_f32 v15, v9, v13
v_cmp_gt_f32 s[88:89], s99, v10
v_fma_f32 v8, -v14, v10, v8
v_fma_f32 v8, v8, v12, v14
v_cndmask_b32 v8, v14, v8, s[88:89]
v_cmp_gt_f32 s[90:91], s99, v11
v_fma_f32 v9, -v15, v11, v9
v_fma_f32 v9, v9, v13, v15
v_cndmask_b32 v9, v15, v9, s[90:91]
v_cvt_pk_bf16_f32 v160, v8, v9
v_lshlrev_b32 v8, 16, v161
v_and_b32 v9, s76, v161
v_mul_f32 v10, s77, v8
v_mul_f32 v11, s77, v9
v_exp_f32 v10, -v10
v_exp_f32 v11, -v11
v_add_f32 v10, 1.0, v10
v_add_f32 v11, 1.0, v11
v_rcp_f32 v12, v10
v_rcp_f32 v13, v11
v_mul_f32 v14, v8, v12
v_mul_f32 v15, v9, v13
v_cmp_gt_f32 s[88:89], s99, v10
v_fma_f32 v8, -v14, v10, v8
v_fma_f32 v8, v8, v12, v14
v_cndmask_b32 v8, v14, v8, s[88:89]
v_cmp_gt_f32 s[90:91], s99, v11
v_fma_f32 v9, -v15, v11, v9
v_fma_f32 v9, v9, v13, v15
v_cndmask_b32 v9, v15, v9, s[90:91]
v_cvt_pk_bf16_f32 v161, v8, v9
v_lshlrev_b32 v8, 16, v162
v_and_b32 v9, s76, v162
v_mul_f32 v10, s77, v8
v_mul_f32 v11, s77, v9
v_exp_f32 v10, -v10
v_exp_f32 v11, -v11
v_add_f32 v10, 1.0, v10
v_add_f32 v11, 1.0, v11
v_rcp_f32 v12, v10
v_rcp_f32 v13, v11
v_mul_f32 v14, v8, v12
v_mul_f32 v15, v9, v13
v_cmp_gt_f32 s[88:89], s99, v10
v_fma_f32 v8, -v14, v10, v8
v_fma_f32 v8, v8, v12, v14
v_cndmask_b32 v8, v14, v8, s[88:89]
v_cmp_gt_f32 s[90:91], s99, v11
v_fma_f32 v9, -v15, v11, v9
v_fma_f32 v9, v9, v13, v15
v_cndmask_b32 v9, v15, v9, s[90:91]
v_cvt_pk_bf16_f32 v162, v8, v9
v_lshlrev_b32 v8, 16, v163
v_and_b32 v9, s76, v163
v_mul_f32 v10, s77, v8
v_mul_f32 v11, s77, v9
v_exp_f32 v10, -v10
v_exp_f32 v11, -v11
v_add_f32 v10, 1.0, v10
v_add_f32 v11, 1.0, v11
v_rcp_f32 v12, v10
v_rcp_f32 v13, v11
v_mul_f32 v14, v8, v12
v_mul_f32 v15, v9, v13
v_cmp_gt_f32 s[88:89], s99, v10
v_fma_f32 v8, -v14, v10, v8
v_fma_f32 v8, v8, v12, v14
v_cndmask_b32 v8, v14, v8, s[88:89]
v_cmp_gt_f32 s[90:91], s99, v11
v_fma_f32 v9, -v15, v11, v9
v_fma_f32 v9, v9, v13, v15
v_cndmask_b32 v9, v15, v9, s[90:91]
v_cvt_pk_bf16_f32 v163, v8, v9
s_mov_b32 s99, 0x7e800000
v_lshlrev_b32 v8, 16, v164
v_and_b32 v9, s76, v164
v_mul_f32 v10, s77, v8
v_mul_f32 v11, s77, v9
v_exp_f32 v10, -v10
v_exp_f32 v11, -v11
v_add_f32 v10, 1.0, v10
v_add_f32 v11, 1.0, v11
v_rcp_f32 v12, v10
v_rcp_f32 v13, v11
v_mul_f32 v14, v8, v12
v_mul_f32 v15, v9, v13
v_cmp_gt_f32 s[88:89], s99, v10
v_fma_f32 v8, -v14, v10, v8
v_fma_f32 v8, v8, v12, v14
v_cndmask_b32 v8, v14, v8, s[88:89]
v_cmp_gt_f32 s[90:91], s99, v11
v_fma_f32 v9, -v15, v11, v9
v_fma_f32 v9, v9, v13, v15
v_cndmask_b32 v9, v15, v9, s[90:91]
v_cvt_pk_bf16_f32 v164, v8, v9
v_lshlrev_b32 v8, 16, v165
v_and_b32 v9, s76, v165
v_mul_f32 v10, s77, v8
v_mul_f32 v11, s77, v9
v_exp_f32 v10, -v10
v_exp_f32 v11, -v11
v_add_f32 v10, 1.0, v10
v_add_f32 v11, 1.0, v11
v_rcp_f32 v12, v10
v_rcp_f32 v13, v11
v_mul_f32 v14, v8, v12
v_mul_f32 v15, v9, v13
v_cmp_gt_f32 s[88:89], s99, v10
v_fma_f32 v8, -v14, v10, v8
v_fma_f32 v8, v8, v12, v14
v_cndmask_b32 v8, v14, v8, s[88:89]
v_cmp_gt_f32 s[90:91], s99, v11
v_fma_f32 v9, -v15, v11, v9
v_fma_f32 v9, v9, v13, v15
v_cndmask_b32 v9, v15, v9, s[90:91]
v_cvt_pk_bf16_f32 v165, v8, v9
v_lshlrev_b32 v8, 16, v166
v_and_b32 v9, s76, v166
v_mul_f32 v10, s77, v8
v_mul_f32 v11, s77, v9
v_exp_f32 v10, -v10
v_exp_f32 v11, -v11
v_add_f32 v10, 1.0, v10
v_add_f32 v11, 1.0, v11
v_rcp_f32 v12, v10
v_rcp_f32 v13, v11
v_mul_f32 v14, v8, v12
v_mul_f32 v15, v9, v13
v_cmp_gt_f32 s[88:89], s99, v10
v_fma_f32 v8, -v14, v10, v8
v_fma_f32 v8, v8, v12, v14
v_cndmask_b32 v8, v14, v8, s[88:89]
v_cmp_gt_f32 s[90:91], s99, v11
v_fma_f32 v9, -v15, v11, v9
v_fma_f32 v9, v9, v13, v15
v_cndmask_b32 v9, v15, v9, s[90:91]
v_cvt_pk_bf16_f32 v166, v8, v9
v_lshlrev_b32 v8, 16, v167
v_and_b32 v9, s76, v167
v_mul_f32 v10, s77, v8
v_mul_f32 v11, s77, v9
v_exp_f32 v10, -v10
v_exp_f32 v11, -v11
v_add_f32 v10, 1.0, v10
v_add_f32 v11, 1.0, v11
v_rcp_f32 v12, v10
v_rcp_f32 v13, v11
v_mul_f32 v14, v8, v12
v_mul_f32 v15, v9, v13
v_cmp_gt_f32 s[88:89], s99, v10
v_fma_f32 v8, -v14, v10, v8
v_fma_f32 v8, v8, v12, v14
v_cndmask_b32 v8, v14, v8, s[88:89]
v_cmp_gt_f32 s[90:91], s99, v11
v_fma_f32 v9, -v15, v11, v9
v_fma_f32 v9, v9, v13, v15
v_cndmask_b32 v9, v15, v9, s[90:91]
v_cvt_pk_bf16_f32 v167, v8, v9
v_mov_b32 v8, 101404
s_mov_b32 s98, 0
LW_18:
ds_read_b32 v9, v8
s_waitcnt lgkmcnt(0)
v_readfirstlane_b32 s79, v9
s_nop 0
s_cmp_ge_u32 s79, 1
s_cbranch_scc1 LX_19
s_sleep 1
s_add_u32 s98, s98, 1
s_cmp_lt_u32 s98, 320000
s_cbranch_scc1 LW_18
LX_19:
buffer_load_dwordx4 v[96:99], v5, s[56:59], s86 offen offset:0 nt
s_add_u32 s7, s86, 6144
buffer_load_dwordx4 v[100:103], v5, s[56:59], s7 offen nt
s_add_u32 s7, s86, 12288
buffer_load_dwordx4 v[104:107], v5, s[56:59], s7 offen nt
s_add_u32 s7, s86, 18432
buffer_load_dwordx4 v[108:111], v5, s[56:59], s7 offen nt
s_add_u32 s7, s86, 24576
buffer_load_dwordx4 v[112:115], v5, s[56:59], s7 offen nt
s_add_u32 s7, s86, 30720
buffer_load_dwordx4 v[116:119], v5, s[56:59], s7 offen nt
s_add_u32 s7, s86, 36864
buffer_load_dwordx4 v[120:123], v5, s[56:59], s7 offen nt
s_add_u32 s7, s86, 43008
buffer_load_dwordx4 v[124:127], v5, s[56:59], s7 offen nt
s_add_u32 s86, s86, 196608
buffer_load_dwordx4 v[64:67], v5, s[56:59], s86 offen offset:0 nt
s_add_u32 s7, s86, 6144
buffer_load_dwordx4 v[68:71], v5, s[56:59], s7 offen nt
s_add_u32 s7, s86, 12288
buffer_load_dwordx4 v[72:75], v5, s[56:59], s7 offen nt
s_add_u32 s7, s86, 18432
buffer_load_dwordx4 v[76:79], v5, s[56:59], s7 offen nt
s_add_u32 s7, s86, 24576
buffer_load_dwordx4 v[80:83], v5, s[56:59], s7 offen nt
s_add_u32 s7, s86, 30720
buffer_load_dwordx4 v[84:87], v5, s[56:59], s7 offen nt
s_add_u32 s7, s86, 36864
buffer_load_dwordx4 v[88:91], v5, s[56:59], s7 offen nt
s_add_u32 s7, s86, 43008
buffer_load_dwordx4 v[92:95], v5, s[56:59], s7 offen nt
s_waitcnt vmcnt(8)
v_cndmask_b32 v8, 0, v160, s[64:65]
v_cndmask_b32 v9, 0, v161, s[64:65]
v_cndmask_b32 v10, 0, v162, s[64:65]
v_cndmask_b32 v11, 0, v163, s[64:65]
v_perm_b32 v12, v100, v96, s74
v_perm_b32 v13, v108, v104, s74
v_perm_b32 v14, v116, v112, s74
v_perm_b32 v15, v124, v120, s74
v_perm_b32 v16, v100, v96, s75
v_perm_b32 v17, v108, v104, s75
v_perm_b32 v18, v116, v112, s75
v_perm_b32 v19, v124, v120, s75
v_mfma_f32_16x16x32_bf16 v[20:23], v[12:15], v[8:11], 0
s_nop 0
v_mfma_f32_16x16x32_bf16 v[24:27], v[16:19], v[8:11], 0
v_cndmask_b32 v8, 0, v160, s[66:67]
v_cndmask_b32 v9, 0, v161, s[66:67]
v_cndmask_b32 v10, 0, v162, s[66:67]
v_cndmask_b32 v11, 0, v163, s[66:67]
v_perm_b32 v12, v101, v97, s74
v_perm_b32 v13, v109, v105, s74
v_perm_b32 v14, v117, v113, s74
v_perm_b32 v15, v125, v121, s74
v_perm_b32 v16, v101, v97, s75
v_perm_b32 v17, v109, v105, s75
v_perm_b32 v18, v117, v113, s75
v_perm_b32 v19, v125, v121, s75
v_mfma_f32_16x16x32_bf16 v[20:23], v[12:15], v[8:11], v[20:23]
s_nop 0
v_mfma_f32_16x16x32_bf16 v[24:27], v[16:19], v[8:11], v[24:27]
v_cndmask_b32 v8, 0, v160, s[68:69]
v_cndmask_b32 v9, 0, v161, s[68:69]
v_cndmask_b32 v10, 0, v162, s[68:69]
v_cndmask_b32 v11, 0, v163, s[68:69]
v_perm_b32 v12, v102, v98, s74
v_perm_b32 v13, v110, v106, s74
v_perm_b32 v14, v118, v114, s74
v_perm_b32 v15, v126, v122, s74
v_perm_b32 v16, v102, v98, s75
v_perm_b32 v17, v110, v106, s75
v_perm_b32 v18, v118, v114, s75
v_perm_b32 v19, v126, v122, s75
v_mfma_f32_16x16x32_bf16 v[20:23], v[12:15], v[8:11], v[20:23]
s_nop 0
v_mfma_f32_16x16x32_bf16 v[24:27], v[16:19], v[8:11], v[24:27]
v_cndmask_b32 v8, 0, v160, s[70:71]
v_cndmask_b32 v9, 0, v161, s[70:71]
v_cndmask_b32 v10, 0, v162, s[70:71]
v_cndmask_b32 v11, 0, v163, s[70:71]
v_perm_b32 v12, v103, v99, s74
v_perm_b32 v13, v111, v107, s74
v_perm_b32 v14, v119, v115, s74
v_perm_b32 v15, v127, v123, s74
v_perm_b32 v16, v103, v99, s75
v_perm_b32 v17, v111, v107, s75
v_perm_b32 v18, v119, v115, s75
v_perm_b32 v19, v127, v123, s75
v_mfma_f32_16x16x32_bf16 v[20:23], v[12:15], v[8:11], v[20:23]
s_nop 0
v_mfma_f32_16x16x32_bf16 v[24:27], v[16:19], v[8:11], v[24:27]
s_waitcnt vmcnt(0)
v_cndmask_b32 v8, 0, v164, s[64:65]
v_cndmask_b32 v9, 0, v165, s[64:65]
v_cndmask_b32 v10, 0, v166, s[64:65]
v_cndmask_b32 v11, 0, v167, s[64:65]
v_perm_b32 v12, v68, v64, s74
v_perm_b32 v13, v76, v72, s74
v_perm_b32 v14, v84, v80, s74
v_perm_b32 v15, v92, v88, s74
v_perm_b32 v16, v68, v64, s75
v_perm_b32 v17, v76, v72, s75
v_perm_b32 v18, v84, v80, s75
v_perm_b32 v19, v92, v88, s75
v_mfma_f32_16x16x32_bf16 v[20:23], v[12:15], v[8:11], v[20:23]
s_nop 0
v_mfma_f32_16x16x32_bf16 v[24:27], v[16:19], v[8:11], v[24:27]
v_cndmask_b32 v8, 0, v164, s[66:67]
v_cndmask_b32 v9, 0, v165, s[66:67]
v_cndmask_b32 v10, 0, v166, s[66:67]
v_cndmask_b32 v11, 0, v167, s[66:67]
v_perm_b32 v12, v69, v65, s74
v_perm_b32 v13, v77, v73, s74
v_perm_b32 v14, v85, v81, s74
v_perm_b32 v15, v93, v89, s74
v_perm_b32 v16, v69, v65, s75
v_perm_b32 v17, v77, v73, s75
v_perm_b32 v18, v85, v81, s75
v_perm_b32 v19, v93, v89, s75
v_mfma_f32_16x16x32_bf16 v[20:23], v[12:15], v[8:11], v[20:23]
s_nop 0
v_mfma_f32_16x16x32_bf16 v[24:27], v[16:19], v[8:11], v[24:27]
v_cndmask_b32 v8, 0, v164, s[68:69]
v_cndmask_b32 v9, 0, v165, s[68:69]
v_cndmask_b32 v10, 0, v166, s[68:69]
v_cndmask_b32 v11, 0, v167, s[68:69]
v_perm_b32 v12, v70, v66, s74
v_perm_b32 v13, v78, v74, s74
v_perm_b32 v14, v86, v82, s74
v_perm_b32 v15, v94, v90, s74
v_perm_b32 v16, v70, v66, s75
v_perm_b32 v17, v78, v74, s75
v_perm_b32 v18, v86, v82, s75
v_perm_b32 v19, v94, v90, s75
v_mfma_f32_16x16x32_bf16 v[20:23], v[12:15], v[8:11], v[20:23]
s_nop 0
v_mfma_f32_16x16x32_bf16 v[24:27], v[16:19], v[8:11], v[24:27]
v_cndmask_b32 v8, 0, v164, s[70:71]
v_cndmask_b32 v9, 0, v165, s[70:71]
v_cndmask_b32 v10, 0, v166, s[70:71]
v_cndmask_b32 v11, 0, v167, s[70:71]
v_perm_b32 v12, v71, v67, s74
v_perm_b32 v13, v79, v75, s74
v_perm_b32 v14, v87, v83, s74
v_perm_b32 v15, v95, v91, s74
v_perm_b32 v16, v71, v67, s75
v_perm_b32 v17, v79, v75, s75
v_perm_b32 v18, v87, v83, s75
v_perm_b32 v19, v95, v91, s75
v_mfma_f32_16x16x32_bf16 v[20:23], v[12:15], v[8:11], v[20:23]
s_nop 0
v_mfma_f32_16x16x32_bf16 v[24:27], v[16:19], v[8:11], v[24:27]
s_lshl_b32 s5, s3, 10
s_add_u32 s5, s5, 84224
v_add_u32 v3, s5, v2
s_nop 4
v_cndmask_b32 v20, v20, v24, s[72:73]
v_cndmask_b32 v21, v21, v25, s[72:73]
v_cndmask_b32 v22, v22, v26, s[72:73]
v_cndmask_b32 v23, v23, v27, s[72:73]
ds_write_b128 v3, v[20:23]
v_mov_b32 v8, 101400
v_mov_b32 v9, 1
s_mov_b64 exec, 1
ds_add_u32 v8, v9
s_mov_b64 exec, -1
s_cmp_lg_u32 s3, 1
s_cbranch_scc1 L_h_end
v_mov_b32 v8, 101400
s_mov_b32 s98, 0
LW_20:
ds_read_b32 v9, v8
s_waitcnt lgkmcnt(0)
v_readfirstlane_b32 s79, v9
s_nop 0
s_cmp_ge_u32 s79, 4
s_cbranch_scc1 LX_21
s_sleep 1
s_add_u32 s98, s98, 1
s_cmp_lt_u32 s98, 320000
s_cbranch_scc1 LW_20
LX_21:
v_add_u32 v3, 84224, v2
ds_read_b128 v[96:99], v3 offset:0
ds_read_b128 v[100:103], v3 offset:1024
ds_read_b128 v[104:107], v3 offset:2048
ds_read_b128 v[108:111], v3 offset:3072
s_waitcnt lgkmcnt(0)
v_add_f32 v96, v96, v100
v_add_f32 v97, v97, v101
v_add_f32 v98, v98, v102
v_add_f32 v99, v99, v103
v_add_f32 v96, v96, v104
v_add_f32 v97, v97, v105
v_add_f32 v98, v98, v106
v_add_f32 v99, v99, v107
v_add_f32 v96, v96, v108
v_add_f32 v97, v97, v109
v_add_f32 v98, v98, v110
v_add_f32 v99, v99, v111
s_add_u32 s5, s80, 8192
buffer_store_dwordx4 v[96:99], v2, s[16:19], s5 offen sc1
L_h_end:
s_endpgm
L_h_q:
s_cmp_lt_u32 s3, 4
s_cbranch_scc1 L_head
s_mov_b32 s30, 0x400000
s_mov_b32 s31, 0x20000
v_lshrrev_b32 v3, 4, v1
v_lshlrev_b32 v3, 14, v3
v_and_b32 v4, 15, v1
v_lshl_add_u32 v3, v4, 4, v3
s_sub_u32 s81, s3, 4
s_lshl_b32 s5, s81, 19
s_lshl_b32 s6, s4, 8
s_add_u32 s82, s5, s6
s_waitcnt lgkmcnt(0)
s_load_dword s96, s[16:17], 0x0
buffer_load_dwordx4 v[32:35], v3, s[28:31], s82 offen offset:0 nt
s_add_u32 s7, s82, 65536
buffer_load_dwordx4 v[36:39], v3, s[28:31], s7 offen nt
s_add_u32 s7, s82, 131072
buffer_load_dwordx4 v[40:43], v3, s[28:31], s7 offen nt
s_add_u32 s7, s82, 196608
buffer_load_dwordx4 v[44:47], v3, s[28:31], s7 offen nt
s_barrier
s_waitcnt vmcnt(3)
s_add_u32 s7, s82, 8192
buffer_load_dwordx4 v[48:51], v3, s[28:31], s7 offen nt
s_waitcnt vmcnt(3)
s_add_u32 s7, s82, 73728
buffer_load_dwordx4 v[52:55], v3, s[28:31], s7 offen nt
s_waitcnt vmcnt(3)
s_add_u32 s7, s82, 139264
buffer_load_dwordx4 v[56:59], v3, s[28:31], s7 offen nt
s_waitcnt vmcnt(3)
s_add_u32 s7, s82, 204800
buffer_load_dwordx4 v[60:63], v3, s[28:31], s7 offen nt
s_add_u32 s82, s82, 262144
s_waitcnt vmcnt(3)
buffer_load_dwordx4 v[64:67], v3, s[28:31], s82 offen offset:0 nt
s_waitcnt vmcnt(3)
s_add_u32 s7, s82, 65536
buffer_load_dwordx4 v[68:71], v3, s[28:31], s7 offen nt
s_waitcnt vmcnt(3)
s_add_u32 s7, s82, 131072
buffer_load_dwordx4 v[72:75], v3, s[28:31], s7 offen nt
s_waitcnt vmcnt(3)
s_add_u32 s7, s82, 196608
buffer_load_dwordx4 v[76:79], v3, s[28:31], s7 offen nt
s_waitcnt vmcnt(3)
s_add_u32 s7, s82, 8192
buffer_load_dwordx4 v[80:83], v3, s[28:31], s7 offen nt
s_waitcnt vmcnt(3)
s_add_u32 s7, s82, 73728
buffer_load_dwordx4 v[84:87], v3, s[28:31], s7 offen nt
s_waitcnt vmcnt(3)
s_add_u32 s7, s82, 139264
buffer_load_dwordx4 v[88:91], v3, s[28:31], s7 offen nt
s_waitcnt vmcnt(3)
s_add_u32 s7, s82, 204800
buffer_load_dwordx4 v[92:95], v3, s[28:31], s7 offen nt
s_mov_b32 s64, 0xf000f
s_mov_b32 s65, 0xf000f
s_mov_b32 s66, 0xf000f0
s_mov_b32 s67, 0xf000f0
s_mov_b32 s68, 0xf000f00
s_mov_b32 s69, 0xf000f00
s_mov_b32 s70, 0xf000f000
s_mov_b32 s71, 0xf000f000
s_mov_b32 s72, 0xcccccccc
s_mov_b32 s73, 0xcccccccc
s_mov_b32 s74, 0x05040100
s_mov_b32 s75, 0x07060302
s_mov_b32 s76, 0xffff0000
s_mov_b32 s77, 0x3fb8aa3b
s_mul_i32 s80, s4, 14976
s_add_u32 s80, s80, 32768
v_lshlrev_b32 v2, 4, v1
s_waitcnt vmcnt(8)
v_perm_b32 v96, v36, v32, s74
v_perm_b32 v100, v36, v32, s75
v_perm_b32 v104, v37, v33, s74
v_perm_b32 v108, v37, v33, s75
v_perm_b32 v112, v38, v34, s74
v_perm_b32 v116, v38, v34, s75
v_perm_b32 v120, v39, v35, s74
v_perm_b32 v124, v39, v35, s75
v_perm_b32 v97, v44, v40, s74
v_perm_b32 v101, v44, v40, s75
v_perm_b32 v105, v45, v41, s74
v_perm_b32 v109, v45, v41, s75
v_perm_b32 v113, v46, v42, s74
v_perm_b32 v117, v46, v42, s75
v_perm_b32 v121, v47, v43, s74
v_perm_b32 v125, v47, v43, s75
v_perm_b32 v98, v52, v48, s74
v_perm_b32 v102, v52, v48, s75
v_perm_b32 v106, v53, v49, s74
v_perm_b32 v110, v53, v49, s75
v_perm_b32 v114, v54, v50, s74
v_perm_b32 v118, v54, v50, s75
v_perm_b32 v122, v55, v51, s74
v_perm_b32 v126, v55, v51, s75
v_perm_b32 v99, v60, v56, s74
v_perm_b32 v103, v60, v56, s75
v_perm_b32 v107, v61, v57, s74
v_perm_b32 v111, v61, v57, s75
v_perm_b32 v115, v62, v58, s74
v_perm_b32 v119, v62, v58, s75
v_perm_b32 v123, v63, v59, s74
v_perm_b32 v127, v63, v59, s75
s_waitcnt vmcnt(0)
v_perm_b32 v128, v68, v64, s74
v_perm_b32 v132, v68, v64, s75
v_perm_b32 v136, v69, v65, s74
v_perm_b32 v140, v69, v65, s75
v_perm_b32 v144, v70, v66, s74
v_perm_b32 v148, v70, v66, s75
v_perm_b32 v152, v71, v67, s74
v_perm_b32 v156, v71, v67, s75
v_perm_b32 v129, v76, v72, s74
v_perm_b32 v133, v76, v72, s75
v_perm_b32 v137, v77, v73, s74
v_perm_b32 v141, v77, v73, s75
v_perm_b32 v145, v78, v74, s74
v_perm_b32 v149, v78, v74, s75
v_perm_b32 v153, v79, v75, s74
v_perm_b32 v157, v79, v75, s75
v_perm_b32 v130, v84, v80, s74
v_perm_b32 v134, v84, v80, s75
v_perm_b32 v138, v85, v81, s74
v_perm_b32 v142, v85, v81, s75
v_perm_b32 v146, v86, v82, s74
v_perm_b32 v150, v86, v82, s75
v_perm_b32 v154, v87, v83, s74
v_perm_b32 v158, v87, v83, s75
v_perm_b32 v131, v92, v88, s74
v_perm_b32 v135, v92, v88, s75
v_perm_b32 v139, v93, v89, s74
v_perm_b32 v143, v93, v89, s75
v_perm_b32 v147, v94, v90, s74
v_perm_b32 v151, v94, v90, s75
v_perm_b32 v155, v95, v91, s74
v_perm_b32 v159, v95, v91, s75
v_and_b32 v28, 1, v1
v_mul_u32_u24 v28, 1088, v28
v_lshrrev_b32 v29, 4, v1
v_lshl_add_u32 v28, v29, 4, v28
v_add_u32 v28, 65536, v28
s_lshl_b32 s6, s81, 7
v_add_u32 v28, s6, v28
v_mov_b32 v29, 100000
v_cndmask_b32 v24, v29, v28, s[64:65]
v_cndmask_b32 v25, v29, v28, s[66:67]
v_cndmask_b32 v26, v29, v28, s[68:69]
v_cndmask_b32 v27, v29, v28, s[70:71]
s_lshl_b32 s5, s81, 10
s_add_u32 s5, s5, 71936
v_add_u32 v3, s5, v2
v_mov_b32 v8, 101392
s_mov_b32 s98, 0
LW_22:
ds_read_b32 v9, v8
s_waitcnt lgkmcnt(0)
v_readfirstlane_b32 s79, v9
s_nop 0
s_cmp_ge_u32 s79, 1
s_cbranch_scc1 LX_23
s_sleep 1
s_add_u32 s98, s98, 1
s_cmp_lt_u32 s98, 320000
s_cbranch_scc1 LW_22
LX_23:
ds_read_b128 v[32:35], v24 offset:0
ds_read_b128 v[36:39], v25 offset:0
ds_read_b128 v[40:43], v26 offset:0
ds_read_b128 v[44:47], v27 offset:0
ds_read_b128 v[48:51], v24 offset:64
ds_read_b128 v[52:55], v25 offset:64
ds_read_b128 v[56:59], v26 offset:64
ds_read_b128 v[60:63], v27 offset:64
s_waitcnt lgkmcnt(7)
v_mfma_f32_16x16x32_bf16 v[64:67], v[96:99], v[32:35], 0
v_mfma_f32_16x16x32_bf16 v[68:71], v[100:103], v[32:35], 0
s_waitcnt lgkmcnt(6)
v_mfma_f32_16x16x32_bf16 v[64:67], v[104:107], v[36:39], v[64:67]
v_mfma_f32_16x16x32_bf16 v[68:71], v[108:111], v[36:39], v[68:71]
s_waitcnt lgkmcnt(5)
v_mfma_f32_16x16x32_bf16 v[64:67], v[112:115], v[40:43], v[64:67]
v_mfma_f32_16x16x32_bf16 v[68:71], v[116:119], v[40:43], v[68:71]
s_waitcnt lgkmcnt(4)
v_mfma_f32_16x16x32_bf16 v[64:67], v[120:123], v[44:47], v[64:67]
v_mfma_f32_16x16x32_bf16 v[68:71], v[124:127], v[44:47], v[68:71]
s_waitcnt lgkmcnt(3)
v_mfma_f32_16x16x32_bf16 v[64:67], v[128:131], v[48:51], v[64:67]
v_mfma_f32_16x16x32_bf16 v[68:71], v[132:135], v[48:51], v[68:71]
s_waitcnt lgkmcnt(2)
v_mfma_f32_16x16x32_bf16 v[64:67], v[136:139], v[52:55], v[64:67]
v_mfma_f32_16x16x32_bf16 v[68:71], v[140:143], v[52:55], v[68:71]
s_waitcnt lgkmcnt(1)
v_mfma_f32_16x16x32_bf16 v[64:67], v[144:147], v[56:59], v[64:67]
v_mfma_f32_16x16x32_bf16 v[68:71], v[148:151], v[56:59], v[68:71]
s_waitcnt lgkmcnt(0)
v_mfma_f32_16x16x32_bf16 v[64:67], v[152:155], v[60:63], v[64:67]
v_mfma_f32_16x16x32_bf16 v[68:71], v[156:159], v[60:63], v[68:71]
s_nop 7
v_cndmask_b32 v64, v64, v68, s[72:73]
v_cndmask_b32 v65, v65, v69, s[72:73]
v_cndmask_b32 v66, v66, v70, s[72:73]
v_cndmask_b32 v67, v67, v71, s[72:73]
ds_write_b128 v3, v[64:67]
v_mov_b32 v8, 101396
v_mov_b32 v9, 1
s_mov_b64 exec, 1
ds_add_u32 v8, v9
s_mov_b64 exec, -1
s_cmp_lg_u32 s3, 4
s_cbranch_scc1 L_h_end
v_lshrrev_b32 v10, 4, v1
v_lshlrev_b32 v10, 5, v10
v_bfe_u32 v11, v1, 1, 3
v_add_u32 v10, v10, v11
v_and_b32 v11, 1, v1
v_lshl_add_u32 v10, v11, 7, v10
v_lshlrev_b32 v10, 1, v10
v_add_u32 v10, 98816, v10
v_lshlrev_b32 v11, 3, v1
v_add_u32 v11, 98816, v11
s_waitcnt lgkmcnt(0)
s_mul_i32 s97, s96, 0x9e3779b1
s_add_u32 s97, s97, 0x85ebca6b
v_mov_b32 v8, 101396
s_mov_b32 s98, 0
LW_24:
ds_read_b32 v9, v8
s_waitcnt lgkmcnt(0)
v_readfirstlane_b32 s79, v9
s_nop 0
s_cmp_ge_u32 s79, 8
s_cbranch_scc1 LX_25
s_sleep 1
s_add_u32 s98, s98, 1
s_cmp_lt_u32 s98, 320000
s_cbranch_scc1 LW_24
LX_25:
v_add_u32 v3, 71936, v2
ds_read_b128 v[96:99], v3 offset:0
ds_read_b128 v[100:103], v3 offset:1024
ds_read_b128 v[104:107], v3 offset:2048
ds_read_b128 v[108:111], v3 offset:3072
ds_read_b128 v[112:115], v3 offset:4096
ds_read_b128 v[116:119], v3 offset:5120
ds_read_b128 v[120:123], v3 offset:6144
ds_read_b128 v[124:127], v3 offset:7168
s_waitcnt lgkmcnt(0)
v_add_f32 v96, v96, v100
v_add_f32 v97, v97, v101
v_add_f32 v98, v98, v102
v_add_f32 v99, v99, v103
v_add_f32 v96, v96, v104
v_add_f32 v97, v97, v105
v_add_f32 v98, v98, v106
v_add_f32 v99, v99, v107
v_add_f32 v96, v96, v108
v_add_f32 v97, v97, v109
v_add_f32 v98, v98, v110
v_add_f32 v99, v99, v111
v_add_f32 v96, v96, v112
v_add_f32 v97, v97, v113
v_add_f32 v98, v98, v114
v_add_f32 v99, v99, v115
v_add_f32 v96, v96, v116
v_add_f32 v97, v97, v117
v_add_f32 v98, v98, v118
v_add_f32 v99, v99, v119
v_add_f32 v96, v96, v120
v_add_f32 v97, v97, v121
v_add_f32 v98, v98, v122
v_add_f32 v99, v99, v123
v_add_f32 v96, v96, v124
v_add_f32 v97, v97, v125
v_add_f32 v98, v98, v126
v_add_f32 v99, v99, v127
v_cvt_pk_bf16_f32 v96, v96, v97
v_cvt_pk_bf16_f32 v98, v98, v99
ds_write_b16 v10, v96
ds_write_b16_d16_hi v10, v96 offset:16
ds_write_b16 v10, v98 offset:32
ds_write_b16_d16_hi v10, v98 offset:48
s_waitcnt lgkmcnt(0)
ds_read_b64 v[100:101], v11
v_mov_b32 v97, s97
v_mov_b32 v99, s97
s_add_u32 s5, s80, 9216
s_waitcnt lgkmcnt(0)
v_mov_b32 v96, v100
v_mov_b32 v98, v101
buffer_store_dwordx4 v[96:99], v2, s[16:19], s5 offen sc1
v_mov_b32 v8, 101404
v_mov_b32 v9, 1
s_mov_b64 exec, 1
ds_add_u32 v8, v9
s_mov_b64 exec, -1
s_endpgm
L_tail:
s_mul_i32 s80, s4, 14976
s_add_u32 s80, s80, 32768
v_lshlrev_b32 v2, 4, v1
s_cmp_ge_u32 s3, 4
s_cbranch_scc1 L_tail_b
s_load_dwordx2 s[32:33], s[0:1], 32
s_load_dwordx2 s[60:61], s[0:1], 96
s_load_dwordx2 s[24:25], s[0:1], 0
s_mov_b32 s34, 0x400000
s_mov_b32 s35, 0x20000
s_mov_b32 s62, 0x800
s_mov_b32 s63, 0x20000
s_mov_b32 s26, 0x800
s_mov_b32 s27, 0x20000
s_mov_b32 s64, 0xf000f
s_mov_b32 s65, 0xf000f
s_mov_b32 s66, 0xf000f0
s_mov_b32 s67, 0xf000f0
s_mov_b32 s68, 0xf000f00
s_mov_b32 s69, 0xf000f00
s_mov_b32 s70, 0xf000f000
s_mov_b32 s71, 0xf000f000
s_mov_b32 s72, 0xcccccccc
s_mov_b32 s73, 0xcccccccc
s_mov_b32 s74, 0x05040100
s_mov_b32 s75, 0x07060302
s_mov_b32 s76, 0xffff0000
s_mov_b32 s77, 0x3fb8aa3b
s_sub_u32 s5, s3, 1
s_and_b32 s5, s5, 1
s_lshl_b32 s81, s5, 10
s_waitcnt lgkmcnt(0)
buffer_load_dwordx4 v[40:43], v2, s[24:27], s81 offen
s_load_dword s96, s[16:17], 0x0
s_cmp_lg_u32 s3, 3
s_cbranch_scc1 L_a_t2
s_getpc_b64 s[92:93]
LH_26:
s_mov_b32 s94, L_c_w1-LH_26
s_mov_b32 s95, 0x20000
s_mov_b32 s5, L_tail_c-LH_26
v_lshlrev_b32 v32, 6, v1
buffer_load_dword v33, v32, s[92:95], s5 offen
s_getpc_b64 s[92:93]
LH_27:
s_mov_b32 s94, L_tail_b-LH_27
s_mov_b32 s95, 0x20000
s_mov_b32 s5, L_h1-LH_27
v_lshlrev_b32 v32, 6, v1
buffer_load_dword v33, v32, s[92:95], s5 offen
L_a_t2:
s_barrier
v_lshrrev_b32 v3, 5, v1
v_lshlrev_b32 v3, 15, v3
v_bfe_u32 v4, v1, 4, 1
v_lshl_add_u32 v3, v4, 11, v3
v_and_b32 v4, 15, v1
v_lshl_add_u32 v35, v4, 4, v3
s_lshl_b32 s5, s4, 17
s_lshl_b32 s6, s3, 8
s_add_u32 s87, s5, s6
s_cmp_lt_u32 s4, 28
s_cbranch_scc1 L_a_wo
s_cmp_eq_u32 s3, 0
s_cbranch_scc1 L_a_h1
s_cmp_eq_u32 s3, 3
s_cbranch_scc1 L_a_h1
s_waitcnt vmcnt(0)
v_lshlrev_b32 v12, 16, v40
v_and_b32 v13, s76, v40
v_lshlrev_b32 v14, 16, v41
v_and_b32 v15, s76, v41
v_lshlrev_b32 v16, 16, v42
v_and_b32 v17, s76, v42
v_lshlrev_b32 v18, 16, v43
v_and_b32 v19, s76, v43
v_add_f32 v20, v12, v13
v_add_f32 v20, v20, v14
v_add_f32 v20, v20, v15
v_add_f32 v20, v20, v16
v_add_f32 v20, v20, v17
v_add_f32 v20, v20, v18
v_add_f32 v20, v20, v19
s_nop 1
v_add_f32_dpp v20, v20, v20 row_ror:8 row_mask:0xf bank_mask:0xf
s_nop 1
v_add_f32_dpp v20, v20, v20 row_ror:4 row_mask:0xf bank_mask:0xf
s_nop 1
v_add_f32_dpp v20, v20, v20 row_ror:2 row_mask:0xf bank_mask:0xf
s_nop 1
v_add_f32_dpp v20, v20, v20 row_ror:1 row_mask:0xf bank_mask:0xf
v_mov_b32 v21, v20
s_nop 1
v_permlane16_swap_b32 v20, v21
v_add_f32 v20, v20, v21
v_mov_b32 v21, v20
s_nop 1
v_permlane32_swap_b32 v20, v21
v_add_f32 v20, v20, v21
v_mul_f32 v20, 0x3b000000, v20
v_mov_b32 v22, 0
v_sub_f32 v21, v12, v20
v_fmac_f32 v22, v21, v21
v_sub_f32 v21, v13, v20
v_fmac_f32 v22, v21, v21
v_sub_f32 v21, v14, v20
v_fmac_f32 v22, v21, v21
v_sub_f32 v21, v15, v20
v_fmac_f32 v22, v21, v21
v_sub_f32 v21, v16, v20
v_fmac_f32 v22, v21, v21
v_sub_f32 v21, v17, v20
v_fmac_f32 v22, v21, v21
v_sub_f32 v21, v18, v20
v_fmac_f32 v22, v21, v21
v_sub_f32 v21, v19, v20
v_fmac_f32 v22, v21, v21
s_nop 1
v_add_f32_dpp v22, v22, v22 row_ror:8 row_mask:0xf bank_mask:0xf
s_nop 1
v_add_f32_dpp v22, v22, v22 row_ror:4 row_mask:0xf bank_mask:0xf
s_nop 1
v_add_f32_dpp v22, v22, v22 row_ror:2 row_mask:0xf bank_mask:0xf
s_nop 1
v_add_f32_dpp v22, v22, v22 row_ror:1 row_mask:0xf bank_mask:0xf
v_mov_b32 v21, v22
s_nop 1
v_permlane16_swap_b32 v22, v21
v_add_f32 v22, v22, v21
v_mov_b32 v21, v22
s_nop 1
v_permlane32_swap_b32 v22, v21
v_add_f32 v22, v22, v21
v_mul_f32 v22, 0x3b000000, v22
v_cvt_pk_bf16_f32 v21, v20, v22
v_lshlrev_b32 v20, 16, v21
v_and_b32 v22, s76, v21
v_add_f32 v22, 0x3727c5ac, v22
v_cvt_pk_bf16_f32 v21, v22, v23
v_lshlrev_b32 v22, 16, v21
v_and_b32 v23, s76, v21
v_sqrt_f32 v22, v22
s_nop 0
v_cvt_pk_bf16_f32 v21, v22, v23
v_lshlrev_b32 v22, 16, v21
v_and_b32 v23, s76, v21
v_rcp_f32 v23, v22
v_sub_f32 v12, v12, v20
v_sub_f32 v13, v13, v20
v_sub_f32 v14, v14, v20
v_sub_f32 v15, v15, v20
v_sub_f32 v16, v16, v20
v_sub_f32 v17, v17, v20
v_sub_f32 v18, v18, v20
v_sub_f32 v19, v19, v20
v_cvt_pk_bf16_f32 v21, v12, v13
v_lshlrev_b32 v12, 16, v21
v_and_b32 v13, s76, v21
v_cvt_pk_bf16_f32 v21, v14, v15
v_lshlrev_b32 v14, 16, v21
v_and_b32 v15, s76, v21
v_cvt_pk_bf16_f32 v21, v16, v17
v_lshlrev_b32 v16, 16, v21
v_and_b32 v17, s76, v21
v_cvt_pk_bf16_f32 v21, v18, v19
v_lshlrev_b32 v18, 16, v21
v_and_b32 v19, s76, v21
v_mul_f32 v24, v12, v23
v_fma_f32 v25, -v24, v22, v12
v_fma_f32 v12, v25, v23, v24
v_mul_f32 v24, v13, v23
v_fma_f32 v25, -v24, v22, v13
v_fma_f32 v13, v25, v23, v24
v_mul_f32 v24, v14, v23
v_fma_f32 v25, -v24, v22, v14
v_fma_f32 v14, v25, v23, v24
v_mul_f32 v24, v15, v23
v_fma_f32 v25, -v24, v22, v15
v_fma_f32 v15, v25, v23, v24
v_mul_f32 v24, v16, v23
v_fma_f32 v25, -v24, v22, v16
v_fma_f32 v16, v25, v23, v24
v_mul_f32 v24, v17, v23
v_fma_f32 v25, -v24, v22, v17
v_fma_f32 v17, v25, v23, v24
v_mul_f32 v24, v18, v23
v_fma_f32 v25, -v24, v22, v18
v_fma_f32 v18, v25, v23, v24
v_mul_f32 v24, v19, v23
v_fma_f32 v25, -v24, v22, v19
v_fma_f32 v19, v25, v23, v24
v_cvt_pk_bf16_f32 v21, v12, v13
v_lshlrev_b32 v12, 16, v21
v_and_b32 v13, s76, v21
v_cvt_pk_bf16_f32 v21, v14, v15
v_lshlrev_b32 v14, 16, v21
v_and_b32 v15, s76, v21
v_cvt_pk_bf16_f32 v21, v16, v17
v_lshlrev_b32 v16, 16, v21
v_and_b32 v17, s76, v21
v_cvt_pk_bf16_f32 v21, v18, v19
v_lshlrev_b32 v18, 16, v21
v_and_b32 v19, s76, v21
v_lshlrev_b32 v21, 5, v1
s_lshl_b32 s5, s81, 1
s_add_u32 s5, s5, 67840
v_add_u32 v21, s5, v21
ds_write_b128 v21, v[12:15]
ds_write_b128 v21, v[16:19] offset:16
v_mov_b32 v8, 101384
v_mov_b32 v9, 1
s_mov_b64 exec, 1
ds_add_u32 v8, v9
s_mov_b64 exec, -1
L_a_h1:
s_call_b64 s[90:91], L_h1
v_mov_b32 v8, 101392
s_mov_b32 s98, 0
LW_28:
ds_read_b32 v9, v8
s_waitcnt lgkmcnt(0)
v_readfirstlane_b32 s79, v9
s_nop 0
s_cmp_ge_u32 s79, 9
s_cbranch_scc1 LX_29
s_sleep 1
s_add_u32 s98, s98, 1
s_cmp_lt_u32 s98, 320000
s_cbranch_scc1 LW_28
LX_29:
L_a_wo:
v_mov_b32 v8, 101392
s_mov_b32 s98, 0
LW_30:
ds_read_b32 v9, v8
s_waitcnt lgkmcnt(0)
v_readfirstlane_b32 s79, v9
s_nop 0
s_cmp_ge_u32 s79, 1
s_cbranch_scc1 LX_31
s_sleep 1
s_add_u32 s98, s98, 1
s_cmp_lt_u32 s98, 320000
s_cbranch_scc1 LW_30
LX_31:
s_cmp_lg_u32 s3, 3
s_cbranch_scc1 L_a_nt
s_getpc_b64 s[92:93]
LH_32:
s_mov_b32 s94, L_exit-LH_32
s_mov_b32 s95, 0x20000
v_lshlrev_b32 v32, 6, v1
s_mov_b32 s5, 0
buffer_load_dword v33, v32, s[92:95], s5 offen
s_mov_b32 s5, 4096
buffer_load_dword v33, v32, s[92:95], s5 offen
s_mov_b32 s5, 8192
buffer_load_dword v33, v32, s[92:95], s5 offen
L_a_nt:
s_add_u32 s82, s87, 69632
buffer_load_dwordx4 v[136:139], v35, s[32:35], s82 offen offset:0 nt
s_add_u32 s7, s82, 8192
buffer_load_dwordx4 v[140:143], v35, s[32:35], s7 offen nt
s_add_u32 s7, s82, 16384
buffer_load_dwordx4 v[144:147], v35, s[32:35], s7 offen nt
s_add_u32 s7, s82, 24576
buffer_load_dwordx4 v[148:151], v35, s[32:35], s7 offen nt
s_waitcnt vmcnt(3)
buffer_load_dwordx4 v[152:155], v35, s[32:35], s82 offen offset:1024 nt
s_waitcnt vmcnt(3)
s_add_u32 s7, s82, 9216
buffer_load_dwordx4 v[156:159], v35, s[32:35], s7 offen nt
s_waitcnt vmcnt(3)
s_add_u32 s7, s82, 17408
buffer_load_dwordx4 v[160:163], v35, s[32:35], s7 offen nt
s_waitcnt vmcnt(3)
s_add_u32 s7, s82, 25600
buffer_load_dwordx4 v[164:167], v35, s[32:35], s7 offen nt
s_add_u32 s82, s87, 0
s_waitcnt vmcnt(3)
buffer_load_dwordx4 v[12:15], v35, s[32:35], s82 offen offset:0 nt
s_waitcnt vmcnt(3)
s_add_u32 s7, s82, 8192
buffer_load_dwordx4 v[20:23], v35, s[32:35], s7 offen nt
s_waitcnt vmcnt(3)
s_add_u32 s7, s82, 16384
buffer_load_dwordx4 v[28:31], v35, s[32:35], s7 offen nt
s_waitcnt vmcnt(3)
s_add_u32 s7, s82, 24576
buffer_load_dwordx4 v[36:39], v35, s[32:35], s7 offen nt
s_waitcnt vmcnt(3)
buffer_load_dwordx4 v[44:47], v35, s[32:35], s82 offen offset:1024 nt
s_waitcnt vmcnt(3)
s_add_u32 s7, s82, 9216
buffer_load_dwordx4 v[52:55], v35, s[32:35], s7 offen nt
s_waitcnt vmcnt(3)
s_add_u32 s7, s82, 17408
buffer_load_dwordx4 v[60:63], v35, s[32:35], s7 offen nt
s_waitcnt vmcnt(3)
s_add_u32 s7, s82, 25600
buffer_load_dwordx4 v[68:71], v35, s[32:35], s7 offen nt
s_add_u32 s82, s87, 65536
s_waitcnt vmcnt(3)
buffer_load_dwordx4 v[72:75], v35, s[32:35], s82 offen offset:0 nt
s_waitcnt vmcnt(3)
s_add_u32 s7, s82, 8192
buffer_load_dwordx4 v[80:83], v35, s[32:35], s7 offen nt
s_waitcnt vmcnt(3)
s_add_u32 s7, s82, 16384
buffer_load_dwordx4 v[88:91], v35, s[32:35], s7 offen nt
s_waitcnt vmcnt(3)
s_add_u32 s7, s82, 24576
buffer_load_dwordx4 v[96:99], v35, s[32:35], s7 offen nt
s_waitcnt vmcnt(3)
buffer_load_dwordx4 v[104:107], v35, s[32:35], s82 offen offset:1024 nt
s_waitcnt vmcnt(3)
s_add_u32 s7, s82, 9216
buffer_load_dwordx4 v[112:115], v35, s[32:35], s7 offen nt
s_waitcnt vmcnt(3)
s_add_u32 s7, s82, 17408
buffer_load_dwordx4 v[120:123], v35, s[32:35], s7 offen nt
s_waitcnt vmcnt(3)
s_add_u32 s7, s82, 25600
buffer_load_dwordx4 v[128:131], v35, s[32:35], s7 offen nt
s_add_u32 s82, s87, 4096
s_waitcnt vmcnt(3)
buffer_load_dwordx4 v[76:79], v35, s[32:35], s82 offen offset:0 nt
s_waitcnt vmcnt(3)
s_add_u32 s7, s82, 8192
buffer_load_dwordx4 v[84:87], v35, s[32:35], s7 offen nt
s_waitcnt vmcnt(3)
s_add_u32 s7, s82, 16384
buffer_load_dwordx4 v[92:95], v35, s[32:35], s7 offen nt
s_waitcnt vmcnt(3)
s_add_u32 s7, s82, 24576
buffer_load_dwordx4 v[100:103], v35, s[32:35], s7 offen nt
s_waitcnt vmcnt(3)
buffer_load_dwordx4 v[108:111], v35, s[32:35], s82 offen offset:1024 nt
s_waitcnt vmcnt(3)
s_add_u32 s7, s82, 9216
buffer_load_dwordx4 v[116:119], v35, s[32:35], s7 offen nt
s_waitcnt vmcnt(3)
s_add_u32 s7, s82, 17408
buffer_load_dwordx4 v[124:127], v35, s[32:35], s7 offen nt
s_waitcnt vmcnt(3)
s_add_u32 s7, s82, 25600
buffer_load_dwordx4 v[132:135], v35, s[32:35], s7 offen nt
v_mov_b32 v8, 101380
v_mov_b32 v9, 1
s_mov_b64 exec, 1
ds_add_u32 v8, v9
s_mov_b64 exec, -1
s_waitcnt vmcnt(16)
v_perm_b32 v8, v20, v12, s74
v_perm_b32 v16, v20, v12, s75
v_perm_b32 v24, v21, v13, s74
v_perm_b32 v32, v21, v13, s75
v_perm_b32 v40, v22, v14, s74
v_perm_b32 v48, v22, v14, s75
v_perm_b32 v56, v23, v15, s74
v_perm_b32 v64, v23, v15, s75
v_perm_b32 v9, v36, v28, s74
v_perm_b32 v17, v36, v28, s75
v_perm_b32 v25, v37, v29, s74
v_perm_b32 v33, v37, v29, s75
v_perm_b32 v41, v38, v30, s74
v_perm_b32 v49, v38, v30, s75
v_perm_b32 v57, v39, v31, s74
v_perm_b32 v65, v39, v31, s75
v_perm_b32 v10, v52, v44, s74
v_perm_b32 v18, v52, v44, s75
v_perm_b32 v26, v53, v45, s74
v_perm_b32 v34, v53, v45, s75
v_perm_b32 v42, v54, v46, s74
v_perm_b32 v50, v54, v46, s75
v_perm_b32 v58, v55, v47, s74
v_perm_b32 v66, v55, v47, s75
v_perm_b32 v11, v68, v60, s74
v_perm_b32 v19, v68, v60, s75
v_perm_b32 v27, v69, v61, s74
v_perm_b32 v35, v69, v61, s75
v_perm_b32 v43, v70, v62, s74
v_perm_b32 v51, v70, v62, s75
v_perm_b32 v59, v71, v63, s74
v_perm_b32 v67, v71, v63, s75
s_waitcnt vmcnt(8)
v_perm_b32 v12, v80, v72, s74
v_perm_b32 v20, v80, v72, s75
v_perm_b32 v28, v81, v73, s74
v_perm_b32 v36, v81, v73, s75
v_perm_b32 v44, v82, v74, s74
v_perm_b32 v52, v82, v74, s75
v_perm_b32 v60, v83, v75, s74
v_perm_b32 v68, v83, v75, s75
v_perm_b32 v13, v96, v88, s74
v_perm_b32 v21, v96, v88, s75
v_perm_b32 v29, v97, v89, s74
v_perm_b32 v37, v97, v89, s75
v_perm_b32 v45, v98, v90, s74
v_perm_b32 v53, v98, v90, s75
v_perm_b32 v61, v99, v91, s74
v_perm_b32 v69, v99, v91, s75
v_perm_b32 v14, v112, v104, s74
v_perm_b32 v22, v112, v104, s75
v_perm_b32 v30, v113, v105, s74
v_perm_b32 v38, v113, v105, s75
v_perm_b32 v46, v114, v106, s74
v_perm_b32 v54, v114, v106, s75
v_perm_b32 v62, v115, v107, s74
v_perm_b32 v70, v115, v107, s75
v_perm_b32 v15, v128, v120, s74
v_perm_b32 v23, v128, v120, s75
v_perm_b32 v31, v129, v121, s74
v_perm_b32 v39, v129, v121, s75
v_perm_b32 v47, v130, v122, s74
v_perm_b32 v55, v130, v122, s75
v_perm_b32 v63, v131, v123, s74
v_perm_b32 v71, v131, v123, s75
s_waitcnt vmcnt(0)
v_perm_b32 v72, v84, v76, s74
v_perm_b32 v80, v84, v76, s75
v_perm_b32 v88, v85, v77, s74
v_perm_b32 v96, v85, v77, s75
v_perm_b32 v104, v86, v78, s74
v_perm_b32 v112, v86, v78, s75
v_perm_b32 v120, v87, v79, s74
v_perm_b32 v128, v87, v79, s75
v_perm_b32 v73, v100, v92, s74
v_perm_b32 v81, v100, v92, s75
v_perm_b32 v89, v101, v93, s74
v_perm_b32 v97, v101, v93, s75
v_perm_b32 v105, v102, v94, s74
v_perm_b32 v113, v102, v94, s75
v_perm_b32 v121, v103, v95, s74
v_perm_b32 v129, v103, v95, s75
v_perm_b32 v74, v116, v108, s74
v_perm_b32 v82, v116, v108, s75
v_perm_b32 v90, v117, v109, s74
v_perm_b32 v98, v117, v109, s75
v_perm_b32 v106, v118, v110, s74
v_perm_b32 v114, v118, v110, s75
v_perm_b32 v122, v119, v111, s74
v_perm_b32 v130, v119, v111, s75
v_perm_b32 v75, v132, v124, s74
v_perm_b32 v83, v132, v124, s75
v_perm_b32 v91, v133, v125, s74
v_perm_b32 v99, v133, v125, s75
v_perm_b32 v107, v134, v126, s74
v_perm_b32 v115, v134, v126, s75
v_perm_b32 v123, v135, v127, s74
v_perm_b32 v131, v135, v127, s75
v_perm_b32 v76, v140, v136, s74
v_perm_b32 v84, v140, v136, s75
v_perm_b32 v92, v141, v137, s74
v_perm_b32 v100, v141, v137, s75
v_perm_b32 v108, v142, v138, s74
v_perm_b32 v116, v142, v138, s75
v_perm_b32 v124, v143, v139, s74
v_perm_b32 v132, v143, v139, s75
v_perm_b32 v77, v148, v144, s74
v_perm_b32 v85, v148, v144, s75
v_perm_b32 v93, v149, v145, s74
v_perm_b32 v101, v149, v145, s75
v_perm_b32 v109, v150, v146, s74
v_perm_b32 v117, v150, v146, s75
v_perm_b32 v125, v151, v147, s74
v_perm_b32 v133, v151, v147, s75
v_perm_b32 v78, v156, v152, s74
v_perm_b32 v86, v156, v152, s75
v_perm_b32 v94, v157, v153, s74
v_perm_b32 v102, v157, v153, s75
v_perm_b32 v110, v158, v154, s74
v_perm_b32 v118, v158, v154, s75
v_perm_b32 v126, v159, v155, s74
v_perm_b32 v134, v159, v155, s75
v_perm_b32 v79, v164, v160, s74
v_perm_b32 v87, v164, v160, s75
v_perm_b32 v95, v165, v161, s74
v_perm_b32 v103, v165, v161, s75
v_perm_b32 v111, v166, v162, s74
v_perm_b32 v119, v166, v162, s75
v_perm_b32 v127, v167, v163, s74
v_perm_b32 v135, v167, v163, s75
v_and_b32 v164, 1, v1
v_mul_u32_u24 v164, 384, v164
v_lshrrev_b32 v165, 4, v1
v_lshl_add_u32 v164, v165, 4, v164
v_add_u32 v164, 99328, v164
v_bfe_u32 v165, v1, 1, 1
v_lshl_add_u32 v164, v165, 6, v164
v_mov_b32 v165, 100000
v_cndmask_b32 v160, v165, v164, s[64:65]
v_cndmask_b32 v161, v165, v164, s[66:67]
v_cndmask_b32 v162, v165, v164, s[68:69]
v_cndmask_b32 v163, v165, v164, s[70:71]
v_mov_b32 v164, 0x4444
v_mov_b32 v165, 0xeeee
v_cndmask_b32 v164, v164, v165, s[72:73]
v_mov_b32 v152, 0
v_mov_b32 v153, 0
v_mov_b32 v154, 0
v_mov_b32 v155, 0
v_mov_b32 v156, 0
v_mov_b32 v157, 0
v_mov_b32 v158, 0
v_mov_b32 v159, 0
s_lshl_b32 s5, s3, 10
s_add_u32 s81, s80, s5
v_mov_b32 v166, 101376
s_mov_b32 s98, 0
LW_33:
ds_read_b32 v167, v166
s_waitcnt lgkmcnt(0)
v_readfirstlane_b32 s78, v167
s_nop 0
s_cmp_ge_u32 s78, 1
s_cbranch_scc1 LX_34
s_sleep 1
s_add_u32 s98, s98, 1
s_cmp_lt_u32 s98, 320000
s_cbranch_scc1 LW_33
LX_34:
s_cmp_eq_u32 s3, 0
s_cbranch_scc0 L_a_pt
v_lshrrev_b32 v3, 3, v1
v_mul_u32_u24 v3, 14976, v3
v_and_b32 v4, 7, v1
v_lshl_add_u32 v3, v4, 4, v3
v_lshrrev_b32 v5, 4, v1
v_lshlrev_b32 v5, 2, v5
v_lshl_add_u32 v4, v4, 4, v5
v_add_u32 v7, 100864, v4
s_lshl_b32 s5, s4, 7
s_add_u32 s82, s5, 32768
s_add_u32 s86, s5, 36864
s_add_u32 s83, s5, 152576
s_add_u32 s87, s5, 156672
s_add_u32 s84, s5, 272384
s_add_u32 s88, s5, 276480
s_add_u32 s85, s5, 392192
s_add_u32 s89, s5, 396288
s_and_b32 s5, s4, 0x18
s_and_b32 s6, s4, 1
s_lshl_b32 s6, s6, 2
s_add_u32 s5, s5, s6
s_bfe_u32 s6, s4, 0x10002
s_add_u32 s5, s5, s6
s_lshl_b32 s5, s5, 6
s_and_b32 s6, s4, 2
s_lshl_b32 s6, s6, 4
s_add_u32 s5, s5, s6
s_add_u32 s90, s5, 516096
v_bfe_u32 v4, v1, 2, 1
v_lshlrev_b32 v4, 7, v4
v_lshrrev_b32 v5, 5, v1
v_lshl_add_u32 v4, v5, 4, v4
v_and_b32 v6, 3, v1
v_lshl_add_u32 v4, v6, 2, v4
v_lshrrev_b32 v5, 4, v1
v_and_b32 v6, 1, v5
v_lshl_add_u32 v4, v6, 11, v4
s_and_b32 s5, s4, 0x18
s_lshl_b32 s5, s5, 5
s_and_b32 s6, s4, 1
s_lshl_b32 s6, s6, 7
s_add_u32 s5, s5, s6
s_and_b32 s6, s4, 6
s_lshl_b32 s6, s6, 1
s_add_u32 s91, s5, s6
v_and_b32 v6, 7, v1
v_lshlrev_b32 v6, 3, v6
v_lshrrev_b32 v165, 5, v1
v_add_u32 v6, v6, v165
v_and_b32 v5, 1, v5
v_lshl_add_u32 v5, v5, 9, v6
v_lshlrev_b32 v5, 1, v5
s_add_u32 s5, s96, 1
v_mov_b32 v166, s5
v_mov_b32 v167, 0
buffer_load_dwordx4 v[136:139], v3, s[16:19], s82 offen sc1
buffer_load_dwordx4 v[136:139], v3, s[16:19], s83 offen sc1
buffer_load_dwordx4 v[136:139], v3, s[16:19], s84 offen sc1
buffer_load_dwordx4 v[136:139], v3, s[16:19], s85 offen sc1
buffer_load_dwordx4 v[136:139], v3, s[16:19], s86 offen sc1
buffer_load_dwordx4 v[136:139], v3, s[16:19], s87 offen sc1
buffer_load_dwordx4 v[136:139], v3, s[16:19], s88 offen sc1
buffer_load_dwordx4 v[136:139], v3, s[16:19], s89 offen sc1
s_branch L_a_pu
L_a_pt:
s_sub_u32 s5, s3, 1
s_and_b32 s5, s5, 1
s_lshl_b32 s6, s5, 4
v_mov_b32 v5, v2
s_lshl_b32 s82, s5, 11
s_add_u32 s82, s82, 516096
s_add_u32 s83, s82, 1024
v_lshlrev_b32 v6, 5, v1
s_add_u32 s6, s6, 88320
v_add_u32 v6, s6, v6
v_lshrrev_b32 v7, 4, v1
v_lshlrev_b32 v7, 7, v7
v_and_b32 v4, 15, v1
v_lshl_add_u32 v7, v4, 2, v7
s_mul_i32 s5, s5, 1152
s_add_u32 s5, s5, 96512
v_add_u32 v7, s5, v7
s_mov_b32 s84, 0x3b000000
v_mov_b32 v3, 0x3727c5ac
buffer_load_dwordx4 v[136:139], v5, s[16:19], s82 offen sc1
buffer_load_dwordx4 v[136:139], v5, s[16:19], s83 offen sc1
L_a_pu:
s_waitcnt vmcnt(0)
s_mov_b64 s[94:95], -1
s_barrier
ds_read_b128 v[136:139], v160 offset:0
ds_read_b128 v[140:143], v161 offset:0
ds_read_b128 v[144:147], v162 offset:0
ds_read_b128 v[148:151], v163 offset:0
s_waitcnt lgkmcnt(3)
v_smfmac_f32_16x16x64_bf16 v[152:155], v[136:139], v[8:15], v164
v_smfmac_f32_16x16x64_bf16 v[156:159], v[136:139], v[16:23], v164
ds_read_b128 v[8:11], v160 offset:128
ds_read_b128 v[12:15], v161 offset:128
ds_read_b128 v[16:19], v162 offset:128
ds_read_b128 v[20:23], v163 offset:128
s_waitcnt lgkmcnt(6)
v_smfmac_f32_16x16x64_bf16 v[152:155], v[140:143], v[24:31], v164
v_smfmac_f32_16x16x64_bf16 v[156:159], v[140:143], v[32:39], v164
s_waitcnt lgkmcnt(5)
v_smfmac_f32_16x16x64_bf16 v[152:155], v[144:147], v[40:47], v164
v_smfmac_f32_16x16x64_bf16 v[156:159], v[144:147], v[48:55], v164
s_waitcnt lgkmcnt(4)
v_smfmac_f32_16x16x64_bf16 v[152:155], v[148:151], v[56:63], v164
v_smfmac_f32_16x16x64_bf16 v[156:159], v[148:151], v[64:71], v164
s_waitcnt lgkmcnt(3)
v_smfmac_f32_16x16x64_bf16 v[152:155], v[8:11], v[72:79], v164
v_smfmac_f32_16x16x64_bf16 v[156:159], v[8:11], v[80:87], v164
s_waitcnt lgkmcnt(2)
v_smfmac_f32_16x16x64_bf16 v[152:155], v[12:15], v[88:95], v164
v_smfmac_f32_16x16x64_bf16 v[156:159], v[12:15], v[96:103], v164
s_waitcnt lgkmcnt(1)
v_smfmac_f32_16x16x64_bf16 v[152:155], v[16:19], v[104:111], v164
v_smfmac_f32_16x16x64_bf16 v[156:159], v[16:19], v[112:119], v164
s_waitcnt lgkmcnt(0)
v_smfmac_f32_16x16x64_bf16 v[152:155], v[20:23], v[120:127], v164
v_smfmac_f32_16x16x64_bf16 v[156:159], v[20:23], v[128:135], v164
s_cmp_eq_u32 s78, 2
s_nop 5
v_pk_add_f32 v[152:153], v[152:153], v[154:155]
v_pk_add_f32 v[154:155], v[156:157], v[158:159]
s_cbranch_scc0 LF_35
buffer_store_dwordx4 v[152:155], v2, s[16:19], s81 offen
LG_36:
s_cmp_lg_u32 s3, 0
s_cbranch_scc1 L_a_ln
ds_read_b32 v72, v7 offset:0
ds_read_b32 v73, v7 offset:128
ds_read_b32 v74, v7 offset:256
ds_read_b32 v75, v7 offset:384
buffer_load_dwordx4 v[8:11], v3, s[16:19], s82 offen sc1
buffer_load_dwordx4 v[12:15], v3, s[16:19], s83 offen sc1
buffer_load_dwordx4 v[16:19], v3, s[16:19], s84 offen sc1
buffer_load_dwordx4 v[20:23], v3, s[16:19], s85 offen sc1
s_mov_b32 s98, 0
LP_37:
buffer_load_dwordx4 v[24:27], v3, s[16:19], s82 offen sc1
buffer_load_dwordx4 v[28:31], v3, s[16:19], s83 offen sc1
buffer_load_dwordx4 v[32:35], v3, s[16:19], s84 offen sc1
buffer_load_dwordx4 v[36:39], v3, s[16:19], s85 offen sc1
s_waitcnt vmcnt(4)
v_pk_add_f32 v[156:157], v[8:9], v[12:13]
v_pk_add_f32 v[158:159], v[10:11], v[14:15]
v_pk_add_f32 v[152:153], v[16:17], v[20:21]
v_pk_add_f32 v[154:155], v[18:19], v[22:23]
v_pk_add_f32 v[156:157], v[156:157], v[152:153]
v_pk_add_f32 v[158:159], v[158:159], v[154:155]
v_cmp_u_f32 vcc, v156, v157
v_cmp_u_f32 s[92:93], v158, v159
s_nop 0
s_or_b64 vcc, vcc, s[92:93]
s_cbranch_vccz LD_38
buffer_load_dwordx4 v[8:11], v3, s[16:19], s82 offen sc1
buffer_load_dwordx4 v[12:15], v3, s[16:19], s83 offen sc1
buffer_load_dwordx4 v[16:19], v3, s[16:19], s84 offen sc1
buffer_load_dwordx4 v[20:23], v3, s[16:19], s85 offen sc1
s_waitcnt vmcnt(4)
v_pk_add_f32 v[156:157], v[24:25], v[28:29]
v_pk_add_f32 v[158:159], v[26:27], v[30:31]
v_pk_add_f32 v[152:153], v[32:33], v[36:37]
v_pk_add_f32 v[154:155], v[34:35], v[38:39]
v_pk_add_f32 v[156:157], v[156:157], v[152:153]
v_pk_add_f32 v[158:159], v[158:159], v[154:155]
v_cmp_u_f32 vcc, v156, v157
v_cmp_u_f32 s[92:93], v158, v159
s_nop 0
s_or_b64 vcc, vcc, s[92:93]
s_cbranch_vccnz LD_38_r
LD_38:
v_permlane32_swap_b32 v156, v158
v_permlane32_swap_b32 v157, v159
v_add_f32 v156, v156, v158
v_add_f32 v157, v157, v159
s_nop 1
v_permlane16_swap_b32 v156, v157
v_add_f32 v156, v156, v157
s_nop 1
v_add_f32_dpp v156, v156, v156 row_ror:8 row_mask:0xf bank_mask:0xf
s_waitcnt lgkmcnt(0)
s_and_b32 exec_lo, 0xff00ff, s94
s_and_b32 exec_hi, 0xff00ff, s95
s_cmp_eq_u32 s78, 2
v_fma_f32 v76, v72, v156, v73
s_cbranch_scc0 LF_40
buffer_store_dword v76, v4, s[16:19], s90 offen
LG_41:
s_mov_b64 exec, s[94:95]
v_mov_b32 v92, 0
v_mov_b32 v108, 0
v_mov_b32 v93, 0
v_mov_b32 v109, 0
v_mov_b32 v94, 0
v_mov_b32 v110, 0
v_mov_b32 v95, 0
v_mov_b32 v111, 0
v_fmac_f32 v76, v74, v75
s_barrier
s_barrier
buffer_load_dwordx4 v[80:83], v3, s[16:19], s86 offen sc1
buffer_load_dwordx4 v[84:87], v3, s[16:19], s87 offen sc1
buffer_load_dwordx4 v[88:91], v3, s[16:19], s88 offen sc1
s_mov_b32 exec_hi, 0
buffer_load_dwordx4 v[92:95], v3, s[16:19], s89 offen sc1
s_mov_b32 exec_hi, s95
s_mov_b32 s98, 0
LP_42:
buffer_load_dwordx4 v[96:99], v3, s[16:19], s86 offen sc1
buffer_load_dwordx4 v[100:103], v3, s[16:19], s87 offen sc1
buffer_load_dwordx4 v[104:107], v3, s[16:19], s88 offen sc1
s_mov_b32 exec_hi, 0
buffer_load_dwordx4 v[108:111], v3, s[16:19], s89 offen sc1
s_mov_b32 exec_hi, s95
s_waitcnt vmcnt(4)
v_pk_add_f32 v[156:157], v[80:81], v[84:85]
v_pk_add_f32 v[158:159], v[82:83], v[86:87]
v_pk_add_f32 v[152:153], v[88:89], v[92:93]
v_pk_add_f32 v[154:155], v[90:91], v[94:95]
v_pk_add_f32 v[156:157], v[156:157], v[152:153]
v_pk_add_f32 v[158:159], v[158:159], v[154:155]
v_cmp_u_f32 vcc, v156, v157
v_cmp_u_f32 s[92:93], v158, v159
s_nop 0
s_or_b64 vcc, vcc, s[92:93]
s_cbranch_vccz LD_43
buffer_load_dwordx4 v[80:83], v3, s[16:19], s86 offen sc1
buffer_load_dwordx4 v[84:87], v3, s[16:19], s87 offen sc1
buffer_load_dwordx4 v[88:91], v3, s[16:19], s88 offen sc1
s_mov_b32 exec_hi, 0
buffer_load_dwordx4 v[92:95], v3, s[16:19], s89 offen sc1
s_mov_b32 exec_hi, s95
s_waitcnt vmcnt(4)
v_pk_add_f32 v[156:157], v[96:97], v[100:101]
v_pk_add_f32 v[158:159], v[98:99], v[102:103]
v_pk_add_f32 v[152:153], v[104:105], v[108:109]
v_pk_add_f32 v[154:155], v[106:107], v[110:111]
v_pk_add_f32 v[156:157], v[156:157], v[152:153]
v_pk_add_f32 v[158:159], v[158:159], v[154:155]
v_cmp_u_f32 vcc, v156, v157
v_cmp_u_f32 s[92:93], v158, v159
s_nop 0
s_or_b64 vcc, vcc, s[92:93]
s_cbranch_vccnz LD_43_r
LD_43:
v_permlane32_swap_b32 v156, v158
v_permlane32_swap_b32 v157, v159
v_add_f32 v156, v156, v158
v_add_f32 v157, v157, v159
s_nop 1
v_permlane16_swap_b32 v156, v157
v_add_f32 v156, v156, v157
s_nop 1
v_add_f32_dpp v156, v156, v156 row_ror:8 row_mask:0xf bank_mask:0xf
s_and_b32 exec_lo, 0xff00ff, s94
s_and_b32 exec_hi, 0xff00ff, s95
v_fmac_f32 v76, v74, v156
v_cvt_pk_bf16_f32 v76, v76, v76
buffer_store_short v76, v5, s[60:63], s91 offen
s_cmp_lg_u32 s4, 0
s_cbranch_scc1 L_a_end
s_and_b32 exec_lo, 0x1, s94
s_and_b32 exec_hi, 0x0, s95
buffer_store_dword v166, v167, s[16:19], 0 offen sc1
L_a_end:
s_endpgm
L_a_ln:
s_cmp_eq_u32 s3, 3
s_cbranch_scc1 L_a_end
s_cmp_ge_u32 s4, 28
s_cbranch_scc1 L_a_end
ds_read_b128 v[72:75], v6
ds_read_b128 v[76:79], v6 offset:2048
ds_read_b128 v[80:83], v6 offset:4096
ds_read_b128 v[84:87], v6 offset:6144
s_mov_b32 s98, 0
LP_50:
buffer_load_dwordx4 v[8:11], v5, s[16:19], s82 offen sc1
buffer_load_dwordx4 v[12:15], v5, s[16:19], s83 offen sc1
s_waitcnt vmcnt(0)
v_max_u32 v165, v8, v9
v_max3_u32 v165, v165, v10, v11
v_max3_u32 v165, v165, v12, v13
v_max3_u32 v165, v165, v14, v15
v_cmp_eq_u32 vcc, -1, v165
s_cbranch_vccz LD_51
s_add_u32 s98, s98, 1
s_cmp_lt_u32 s98, 40000
s_cbranch_scc1 LP_50
LD_51:
v_readfirstlane_b32 s6, v8
s_nop 1
v_pk_add_f32 v[88:89], v[8:9], s[6:7] op_sel_hi:[1,0] neg_lo:[0,1] neg_hi:[0,1]
v_pk_add_f32 v[90:91], v[10:11], s[6:7] op_sel_hi:[1,0] neg_lo:[0,1] neg_hi:[0,1]
v_pk_add_f32 v[92:93], v[12:13], s[6:7] op_sel_hi:[1,0] neg_lo:[0,1] neg_hi:[0,1]
v_pk_add_f32 v[94:95], v[14:15], s[6:7] op_sel_hi:[1,0] neg_lo:[0,1] neg_hi:[0,1]
v_pk_mul_f32 v[98:99], v[88:89], v[88:89]
v_pk_add_f32 v[96:97], v[88:89], v[90:91]
v_pk_fma_f32 v[98:99], v[90:91], v[90:91], v[98:99]
v_pk_add_f32 v[100:101], v[92:93], v[94:95]
v_pk_fma_f32 v[98:99], v[92:93], v[92:93], v[98:99]
v_pk_add_f32 v[96:97], v[96:97], v[100:101]
v_pk_fma_f32 v[98:99], v[94:95], v[94:95], v[98:99]
v_add_f32 v156, v96, v97
v_add_f32 v157, v98, v99
s_nop 1
v_permlane32_swap_b32 v156, v157
v_add_f32 v156, v156, v157
v_mov_b32 v157, v156
s_nop 1
v_permlane16_swap_b32 v156, v157
v_add_f32 v156, v156, v157
s_nop 1
v_add_f32_dpp v156, v156, v156 row_ror:8 row_mask:0xf bank_mask:0xf
s_nop 1
v_add_f32_dpp v156, v156, v156 row_ror:4 row_mask:0xf bank_mask:0xf
s_nop 1
v_add_f32_dpp v156, v156, v156 row_ror:2 row_mask:0xf bank_mask:0xf
s_nop 1
v_add_f32_dpp v156, v156, v156 row_ror:1 row_mask:0xf bank_mask:0xf
s_nop 0
v_readlane_b32 s6, v156, 0
v_readlane_b32 s5, v156, 32
v_mov_b32 v159, s84
v_mul_f32 v156, s6, v159
v_fma_f32 v158, s5, v159, v3
v_fma_f32 v158, -v156, v156, v158
v_max_f32 v158, v158, v3
v_rsq_f32 v158, v158
v_pk_add_f32 v[88:89], v[88:89], v[156:157] op_sel_hi:[1,0] neg_lo:[0,1] neg_hi:[0,1]
v_pk_add_f32 v[90:91], v[90:91], v[156:157] op_sel_hi:[1,0] neg_lo:[0,1] neg_hi:[0,1]
v_pk_add_f32 v[92:93], v[92:93], v[156:157] op_sel_hi:[1,0] neg_lo:[0,1] neg_hi:[0,1]
v_pk_add_f32 v[94:95], v[94:95], v[156:157] op_sel_hi:[1,0] neg_lo:[0,1] neg_hi:[0,1]
s_waitcnt lgkmcnt(0)
v_pk_mul_f32 v[88:89], v[88:89], v[72:73]
v_pk_mul_f32 v[90:91], v[90:91], v[74:75]
v_pk_mul_f32 v[92:93], v[92:93], v[76:77]
v_pk_mul_f32 v[94:95], v[94:95], v[78:79]
v_pk_fma_f32 v[88:89], v[88:89], v[158:159], v[80:81] op_sel_hi:[1,0,1]
v_pk_fma_f32 v[90:91], v[90:91], v[158:159], v[82:83] op_sel_hi:[1,0,1]
v_pk_fma_f32 v[92:93], v[92:93], v[158:159], v[84:85] op_sel_hi:[1,0,1]
v_pk_fma_f32 v[94:95], v[94:95], v[158:159], v[86:87] op_sel_hi:[1,0,1]
v_pk_mul_f32 v[98:99], v[88:89], v[88:89]
v_pk_add_f32 v[96:97], v[88:89], v[90:91]
v_pk_fma_f32 v[98:99], v[90:91], v[90:91], v[98:99]
v_pk_add_f32 v[100:101], v[92:93], v[94:95]
v_pk_fma_f32 v[98:99], v[92:93], v[92:93], v[98:99]
v_pk_add_f32 v[96:97], v[96:97], v[100:101]
v_pk_fma_f32 v[98:99], v[94:95], v[94:95], v[98:99]
v_add_f32 v156, v96, v97
v_add_f32 v157, v98, v99
s_nop 1
v_permlane32_swap_b32 v156, v157
v_add_f32 v156, v156, v157
v_mov_b32 v157, v156
s_nop 1
v_permlane16_swap_b32 v156, v157
v_add_f32 v156, v156, v157
s_nop 1
v_add_f32_dpp v156, v156, v156 row_ror:8 row_mask:0xf bank_mask:0xf
s_nop 1
v_add_f32_dpp v156, v156, v156 row_ror:4 row_mask:0xf bank_mask:0xf
s_nop 1
v_add_f32_dpp v156, v156, v156 row_ror:2 row_mask:0xf bank_mask:0xf
s_nop 1
v_add_f32_dpp v156, v156, v156 row_ror:1 row_mask:0xf bank_mask:0xf
s_nop 0
v_readlane_b32 s6, v156, 0
v_readlane_b32 s5, v156, 32
v_mov_b32 v159, s84
v_mul_f32 v156, s6, v159
v_fma_f32 v158, s5, v159, v3
v_fma_f32 v158, -v156, v156, v158
v_max_f32 v158, v158, v3
v_rsq_f32 v158, v158
v_pk_add_f32 v[88:89], v[88:89], v[156:157] op_sel_hi:[1,0] neg_lo:[0,1] neg_hi:[0,1]
v_pk_add_f32 v[90:91], v[90:91], v[156:157] op_sel_hi:[1,0] neg_lo:[0,1] neg_hi:[0,1]
v_pk_add_f32 v[92:93], v[92:93], v[156:157] op_sel_hi:[1,0] neg_lo:[0,1] neg_hi:[0,1]
v_pk_add_f32 v[94:95], v[94:95], v[156:157] op_sel_hi:[1,0] neg_lo:[0,1] neg_hi:[0,1]
v_pk_mul_f32 v[88:89], v[88:89], v[158:159] op_sel_hi:[1,0]
v_pk_mul_f32 v[90:91], v[90:91], v[158:159] op_sel_hi:[1,0]
v_pk_mul_f32 v[92:93], v[92:93], v[158:159] op_sel_hi:[1,0]
v_pk_mul_f32 v[94:95], v[94:95], v[158:159] op_sel_hi:[1,0]
v_cvt_pk_bf16_f32 v88, v88, v89
v_cvt_pk_bf16_f32 v89, v90, v91
v_cvt_pk_bf16_f32 v90, v92, v93
v_cvt_pk_bf16_f32 v91, v94, v95
ds_write2_b32 v7, v88, v89 offset1:16
ds_write2_b32 v7, v90, v91 offset0:128 offset1:144
s_waitcnt lgkmcnt(0)
s_barrier
s_branch L_a_end
LF_35:
buffer_store_dwordx4 v[152:155], v2, s[16:19], s81 offen sc1
s_branch LG_36
LD_38_r:
s_add_u32 s98, s98, 1
s_and_b32 s5, s98, 31
s_cbranch_scc1 LP_37
v_max_u32 v165, v24, v25
v_max3_u32 v165, v165, v26, v27
v_max3_u32 v165, v165, v28, v29
v_max3_u32 v165, v165, v30, v31
v_max3_u32 v165, v165, v32, v33
v_max3_u32 v165, v165, v34, v35
v_max3_u32 v165, v165, v36, v37
v_max3_u32 v165, v165, v38, v39
v_cmp_eq_u32 vcc, -1, v165
s_cbranch_vccz LD_38
s_cmp_lt_u32 s98, 40000
s_cbranch_scc1 LP_37
s_branch LD_38
LF_40:
buffer_store_dword v76, v4, s[16:19], s90 offen sc1
s_branch LG_41
LD_43_r:
s_add_u32 s98, s98, 1
s_and_b32 s5, s98, 31
s_cbranch_scc1 LP_42
v_max_u32 v165, v96, v97
v_max3_u32 v165, v165, v98, v99
v_max3_u32 v165, v165, v100, v101
v_max3_u32 v165, v165, v102, v103
v_max3_u32 v165, v165, v104, v105
v_max3_u32 v165, v165, v106, v107
v_max3_u32 v165, v165, v108, v109
v_max3_u32 v165, v165, v110, v111
v_cmp_eq_u32 vcc, -1, v165
s_cbranch_vccz LD_43
s_cmp_lt_u32 s98, 40000
s_cbranch_scc1 LP_42
s_branch LD_43
L_h1:
s_sub_u32 s93, s4, 28
s_lshl_b32 s93, s93, 3
s_add_u32 s93, s93, s3
v_lshrrev_b32 v3, 5, v1
v_lshlrev_b32 v3, 4, v3
v_bfe_u32 v4, v1, 3, 2
v_add_u32 v3, v3, v4
v_mul_u32_u24 v3, 14976, v3
v_and_b32 v4, 7, v1
v_lshl_add_u32 v3, v4, 4, v3
s_lshr_b32 s5, s93, 3
s_mul_i32 s5, s5, 59904
s_and_b32 s6, s93, 7
s_lshl_b32 s6, s6, 7
s_add_u32 s5, s5, s6
s_add_u32 s82, s5, 43520
s_lshr_b32 s5, s93, 1
s_lshl_b32 s5, s5, 5
s_and_b32 s6, s93, 1
s_lshl_b32 s6, s6, 2
s_add_u32 s5, s5, s6
s_lshl_b32 s5, s5, 2
s_add_u32 s5, s5, 67840
v_bfe_u32 v5, v1, 1, 2
v_and_b32 v6, 1, v1
v_lshlrev_b32 v7, 4, v5
v_lshl_add_u32 v7, v6, 6, v7
v_lshl_add_u32 v5, v6, 9, v5
v_lshlrev_b32 v5, 2, v5
v_add_u32 v5, s5, v5
s_mul_i32 s83, s93, 14976
s_add_u32 s83, s83, 43392
v_mov_b32 v8, 101384
s_mov_b32 s98, 0
LW_53:
ds_read_b32 v9, v8
s_waitcnt lgkmcnt(0)
v_readfirstlane_b32 s79, v9
s_nop 0
s_cmp_ge_u32 s79, 2
s_cbranch_scc1 LX_54
s_sleep 1
s_add_u32 s98, s98, 1
s_cmp_lt_u32 s98, 320000
s_cbranch_scc1 LW_53
LX_54:
ds_read_b32 v24, v5 offset:0
ds_read_b32 v25, v5 offset:32
ds_read_b32 v26, v5 offset:64
ds_read_b32 v27, v5 offset:96
s_waitcnt lgkmcnt(0)
s_mul_i32 s97, s96, 0x9e3779b1
s_add_u32 s97, s97, 0x85ebca6b
s_mov_b32 s98, 0
L_a_mp:
s_and_b32 s5, s98, 63
s_cmp_eq_u32 s5, 63
s_cselect_b32 s5, 2048, 0
s_add_u32 s5, s5, s82
buffer_load_dwordx4 v[16:19], v3, s[16:19], s5 offen sc1
buffer_load_dwordx4 v[20:23], v3, s[16:19], s5 offen offset:1024 sc1
s_waitcnt vmcnt(0)
v_cmp_ne_u32 vcc, s97, v17
v_cmp_ne_u32 s[88:89], s97, v19
s_nop 0
s_or_b64 vcc, vcc, s[88:89]
v_cmp_ne_u32 s[88:89], s97, v21
s_nop 0
s_or_b64 vcc, vcc, s[88:89]
v_cmp_ne_u32 s[88:89], s97, v23
s_nop 0
s_or_b64 vcc, vcc, s[88:89]
s_cmp_eq_u64 vcc, 0
s_cbranch_scc1 L_a_mq
s_add_u32 s98, s98, 1
s_cmp_lt_u32 s98, 40000
s_cbranch_scc1 L_a_mp
L_a_mq:
v_add_f32_dpp v12, v16, v16 row_ror:8 row_mask:0xf bank_mask:0xf
v_add_f32_dpp v13, v18, v18 row_ror:8 row_mask:0xf bank_mask:0xf
v_add_f32_dpp v14, v20, v20 row_ror:8 row_mask:0xf bank_mask:0xf
v_add_f32_dpp v15, v22, v22 row_ror:8 row_mask:0xf bank_mask:0xf
v_mov_b32 v16, v12
v_mov_b32 v17, v13
v_mov_b32 v18, v14
v_mov_b32 v19, v15
v_permlane16_swap_b32 v12, v16
v_permlane16_swap_b32 v13, v17
v_permlane16_swap_b32 v14, v18
v_permlane16_swap_b32 v15, v19
v_add_f32 v12, v12, v16
v_add_f32 v13, v13, v17
v_add_f32 v14, v14, v18
v_add_f32 v15, v15, v19
v_mov_b32 v16, v12
v_mov_b32 v17, v13
v_mov_b32 v18, v14
v_mov_b32 v19, v15
v_permlane32_swap_b32 v12, v16
v_permlane32_swap_b32 v13, v17
v_permlane32_swap_b32 v14, v18
v_permlane32_swap_b32 v15, v19
v_cvt_pk_bf16_f32 v8, v12, v13
v_lshlrev_b32 v12, 16, v8
v_and_b32 v13, s76, v8
v_cvt_pk_bf16_f32 v8, v14, v15
v_lshlrev_b32 v14, 16, v8
v_and_b32 v15, s76, v8
v_cvt_pk_bf16_f32 v8, v16, v17
v_lshlrev_b32 v16, 16, v8
v_and_b32 v17, s76, v8
v_cvt_pk_bf16_f32 v8, v18, v19
v_lshlrev_b32 v18, 16, v8
v_and_b32 v19, s76, v8
v_add_f32 v16, 1.0, v16
v_add_f32 v17, 1.0, v17
v_add_f32 v18, 1.0, v18
v_add_f32 v19, 1.0, v19
v_cvt_pk_bf16_f32 v8, v16, v17
v_lshlrev_b32 v16, 16, v8
v_and_b32 v17, s76, v8
v_cvt_pk_bf16_f32 v8, v18, v19
v_lshlrev_b32 v18, 16, v8
v_and_b32 v19, s76, v8
v_mul_f32 v24, v24, v16
v_mul_f32 v25, v25, v17
v_mul_f32 v26, v26, v18
v_mul_f32 v27, v27, v19
v_cvt_pk_bf16_f32 v8, v24, v25
v_lshlrev_b32 v24, 16, v8
v_and_b32 v25, s76, v8
v_cvt_pk_bf16_f32 v8, v26, v27
v_lshlrev_b32 v26, 16, v8
v_and_b32 v27, s76, v8
v_add_f32 v24, v24, v12
v_add_f32 v25, v25, v13
v_add_f32 v26, v26, v14
v_add_f32 v27, v27, v15
v_cvt_pk_bf16_f32 v24, v24, v25
v_cvt_pk_bf16_f32 v26, v26, v27
v_mov_b32 v25, s97
v_mov_b32 v27, s97
s_mov_b64 exec, 0xff
buffer_store_dwordx4 v[24:27], v7, s[16:19], s83 offen sc1
s_mov_b64 exec, -1
v_mov_b32 v8, 101392
v_mov_b32 v9, 1
s_mov_b64 exec, 1
ds_add_u32 v8, v9
s_mov_b64 exec, -1
s_setpc_b64 s[90:91]
L_tail_b:
s_load_dwordx2 s[44:45], s[0:1], 64
s_mov_b32 s46, 0x1c0000
s_mov_b32 s47, 0x20000
s_mov_b32 s64, 0xf000f
s_mov_b32 s65, 0xf000f
s_mov_b32 s66, 0xf000f0
s_mov_b32 s67, 0xf000f0
s_mov_b32 s68, 0xf000f00
s_mov_b32 s69, 0xf000f00
s_mov_b32 s70, 0xf000f000
s_mov_b32 s71, 0xf000f000
s_mov_b32 s72, 0xcccccccc
s_mov_b32 s73, 0xcccccccc
s_mov_b32 s74, 0x05040100
s_mov_b32 s75, 0x07060302
s_mov_b32 s76, 0xffff0000
s_mov_b32 s77, 0x3fb8aa3b
s_sub_u32 s81, s3, 4
v_lshrrev_b32 v3, 4, v1
v_mul_u32_u24 v3, 8192, v3
v_and_b32 v4, 15, v1
v_lshl_add_u32 v3, v4, 4, v3
s_lshl_b32 s5, s4, 16
s_lshl_b32 s6, s81, 8
s_add_u32 s82, s5, s6
s_waitcnt lgkmcnt(0)
s_load_dword s96, s[16:17], 0x0
s_cmp_eq_u32 s3, 5
s_cbranch_scc0 L_b_ni
v_mov_b32 v8, 0
v_lshlrev_b32 v9, 2, v1
v_add_u32 v10, 100000, v9
ds_write_b32 v10, v8
v_add_u32 v10, 101376, v9
s_mov_b64 exec, 0xffff
ds_write_b32 v10, v8
s_mov_b64 exec, -1
s_waitcnt lgkmcnt(0)
L_b_ni:
s_cmp_eq_u32 s3, 4
s_cbranch_scc0 L_b_nc
v_mov_b32 v8, -1
v_mov_b32 v9, -1
v_mov_b32 v10, -1
v_mov_b32 v11, -1
s_add_u32 s5, s80, 0
buffer_store_dwordx4 v[8:11], v2, s[16:19], s5 offen offset:0 sc1
buffer_store_dwordx4 v[8:11], v2, s[16:19], s5 offen offset:1024 sc1
buffer_store_dwordx4 v[8:11], v2, s[16:19], s5 offen offset:2048 sc1
buffer_store_dwordx4 v[8:11], v2, s[16:19], s5 offen offset:3072 sc1
s_add_u32 s5, s80, 4096
buffer_store_dwordx4 v[8:11], v2, s[16:19], s5 offen offset:0 sc1
buffer_store_dwordx4 v[8:11], v2, s[16:19], s5 offen offset:1024 sc1
buffer_store_dwordx4 v[8:11], v2, s[16:19], s5 offen offset:2048 sc1
buffer_store_dwordx4 v[8:11], v2, s[16:19], s5 offen offset:3072 sc1
s_add_u32 s5, s80, 10368
s_lshl_b32 s6, s4, 7
s_add_u32 s6, s6, 516096
s_mov_b64 exec, 0xffff
buffer_store_dwordx4 v[8:11], v2, s[16:19], s5 offen sc1
s_mov_b64 exec, 0xff
buffer_store_dwordx4 v[8:11], v2, s[16:19], s6 offen sc1
s_mov_b64 exec, -1
s_barrier
s_getreg_b32 s5, hwreg(HW_REG_XCC_ID)
s_and_b32 s5, s5, 7
s_mul_i32 s6, s5, s5
s_lshl_b32 s6, s6, 16
s_lshl_b32 s5, s5, 8
s_add_u32 s5, s5, s6
s_add_u32 s85, s5, 1
v_mov_b32 v12, s85
v_mov_b32 v13, 0
s_waitcnt vmcnt(0)
s_mov_b64 exec, 1
buffer_atomic_add v12, v13, s[20:23], 0 offen offset:4 sc1
s_mov_b64 exec, -1
s_cmp_lt_u32 s4, 28
s_cbranch_scc1 L_b_nh
s_call_b64 s[90:91], L_h1
v_mov_b32 v13, 0
L_b_nh:
s_branch L_b_w2
L_b_nc:
s_barrier
s_cmp_lt_u32 s4, 28
s_cbranch_scc1 L_b_w2
s_call_b64 s[90:91], L_h1
L_b_w2:
s_cmp_ge_u32 s4, 28
s_cbranch_scc1 L_b_now2
buffer_load_dwordx4 v[32:35], v3, s[44:47], s82 offen offset:0 nt
buffer_load_dwordx4 v[36:39], v3, s[44:47], s82 offen offset:1024 nt
buffer_load_dwordx4 v[40:43], v3, s[44:47], s82 offen offset:2048 nt
buffer_load_dwordx4 v[44:47], v3, s[44:47], s82 offen offset:3072 nt
s_add_u32 s7, s82, 4096
buffer_load_dwordx4 v[48:51], v3, s[44:47], s7 offen nt
s_add_u32 s7, s82, 5120
buffer_load_dwordx4 v[52:55], v3, s[44:47], s7 offen nt
s_add_u32 s7, s82, 6144
buffer_load_dwordx4 v[56:59], v3, s[44:47], s7 offen nt
s_add_u32 s7, s82, 7168
buffer_load_dwordx4 v[60:63], v3, s[44:47], s7 offen nt
v_mov_b32 v8, 101392
s_mov_b32 s98, 0
LW_55:
ds_read_b32 v9, v8
s_waitcnt lgkmcnt(0)
v_readfirstlane_b32 s79, v9
s_nop 0
s_cmp_ge_u32 s79, 1
s_cbranch_scc1 LX_56
s_sleep 1
s_add_u32 s98, s98, 1
s_cmp_lt_u32 s98, 320000
s_cbranch_scc1 LW_55
LX_56:
s_add_u32 s82, s82, 32768
s_waitcnt vmcnt(1)
buffer_load_dwordx4 v[64:67], v3, s[44:47], s82 offen offset:0 nt
s_waitcnt vmcnt(1)
buffer_load_dwordx4 v[68:71], v3, s[44:47], s82 offen offset:1024 nt
s_waitcnt vmcnt(1)
buffer_load_dwordx4 v[72:75], v3, s[44:47], s82 offen offset:2048 nt
s_waitcnt vmcnt(1)
buffer_load_dwordx4 v[76:79], v3, s[44:47], s82 offen offset:3072 nt
s_waitcnt vmcnt(1)
s_add_u32 s7, s82, 4096
buffer_load_dwordx4 v[80:83], v3, s[44:47], s7 offen nt
s_waitcnt vmcnt(1)
s_add_u32 s7, s82, 5120
buffer_load_dwordx4 v[84:87], v3, s[44:47], s7 offen nt
s_waitcnt vmcnt(1)
s_add_u32 s7, s82, 6144
buffer_load_dwordx4 v[88:91], v3, s[44:47], s7 offen nt
s_waitcnt vmcnt(1)
s_add_u32 s7, s82, 7168
buffer_load_dwordx4 v[92:95], v3, s[44:47], s7 offen nt
s_waitcnt vmcnt(0)
v_perm_b32 v96, v36, v32, s74
v_perm_b32 v104, v36, v32, s75
v_perm_b32 v112, v37, v33, s74
v_perm_b32 v120, v37, v33, s75
v_perm_b32 v128, v38, v34, s74
v_perm_b32 v136, v38, v34, s75
v_perm_b32 v144, v39, v35, s74
v_perm_b32 v152, v39, v35, s75
v_perm_b32 v97, v44, v40, s74
v_perm_b32 v105, v44, v40, s75
v_perm_b32 v113, v45, v41, s74
v_perm_b32 v121, v45, v41, s75
v_perm_b32 v129, v46, v42, s74
v_perm_b32 v137, v46, v42, s75
v_perm_b32 v145, v47, v43, s74
v_perm_b32 v153, v47, v43, s75
v_perm_b32 v98, v52, v48, s74
v_perm_b32 v106, v52, v48, s75
v_perm_b32 v114, v53, v49, s74
v_perm_b32 v122, v53, v49, s75
v_perm_b32 v130, v54, v50, s74
v_perm_b32 v138, v54, v50, s75
v_perm_b32 v146, v55, v51, s74
v_perm_b32 v154, v55, v51, s75
v_perm_b32 v99, v60, v56, s74
v_perm_b32 v107, v60, v56, s75
v_perm_b32 v115, v61, v57, s74
v_perm_b32 v123, v61, v57, s75
v_perm_b32 v131, v62, v58, s74
v_perm_b32 v139, v62, v58, s75
v_perm_b32 v147, v63, v59, s74
v_perm_b32 v155, v63, v59, s75
v_perm_b32 v100, v68, v64, s74
v_perm_b32 v108, v68, v64, s75
v_perm_b32 v116, v69, v65, s74
v_perm_b32 v124, v69, v65, s75
v_perm_b32 v132, v70, v66, s74
v_perm_b32 v140, v70, v66, s75
v_perm_b32 v148, v71, v67, s74
v_perm_b32 v156, v71, v67, s75
v_perm_b32 v101, v76, v72, s74
v_perm_b32 v109, v76, v72, s75
v_perm_b32 v117, v77, v73, s74
v_perm_b32 v125, v77, v73, s75
v_perm_b32 v133, v78, v74, s74
v_perm_b32 v141, v78, v74, s75
v_perm_b32 v149, v79, v75, s74
v_perm_b32 v157, v79, v75, s75
v_perm_b32 v102, v84, v80, s74
v_perm_b32 v110, v84, v80, s75
v_perm_b32 v118, v85, v81, s74
v_perm_b32 v126, v85, v81, s75
v_perm_b32 v134, v86, v82, s74
v_perm_b32 v142, v86, v82, s75
v_perm_b32 v150, v87, v83, s74
v_perm_b32 v158, v87, v83, s75
v_perm_b32 v103, v92, v88, s74
v_perm_b32 v111, v92, v88, s75
v_perm_b32 v119, v93, v89, s74
v_perm_b32 v127, v93, v89, s75
v_perm_b32 v135, v94, v90, s74
v_perm_b32 v143, v94, v90, s75
v_perm_b32 v151, v95, v91, s74
v_perm_b32 v159, v95, v91, s75
L_b_now2:
v_mov_b32 v8, 101376
s_mov_b32 s98, 0
LW_57:
ds_read_b32 v9, v8
s_waitcnt lgkmcnt(0)
v_readfirstlane_b32 s78, v9
s_nop 0
s_cmp_ge_u32 s78, 1
s_cbranch_scc1 LX_58
s_sleep 1
s_add_u32 s98, s98, 1
s_cmp_lt_u32 s98, 320000
s_cbranch_scc1 LW_57
LX_58:
s_lshr_b32 s82, s81, 1
v_lshrrev_b32 v4, 4, v1
v_add_u32 v8, 0, v4
v_add_u32 v9, 4, v4
v_add_u32 v10, 8, v4
v_lshlrev_b32 v17, 3, v8
v_lshlrev_b32 v18, 3, v9
v_lshlrev_b32 v19, 3, v10
s_mul_i32 s5, s82, 96
s_add_u32 s85, s80, s5
s_add_u32 s85, s85, 10368
v_and_b32 v5, 15, v1
v_lshlrev_b32 v12, 11, v8
v_lshl_add_u32 v12, v5, 4, v12
v_lshlrev_b32 v13, 11, v9
v_lshl_add_u32 v13, v5, 4, v13
v_lshlrev_b32 v14, 11, v10
v_lshl_add_u32 v14, v5, 4, v14
s_lshl_b32 s5, s82, 3
s_lshr_b32 s6, s4, 2
s_add_u32 s5, s5, s6
s_mul_i32 s5, s5, 24576
s_and_b32 s6, s4, 3
s_lshl_b32 s6, s6, 9
s_add_u32 s5, s5, s6
s_and_b32 s6, s81, 1
s_lshl_b32 s6, s6, 8
s_add_u32 s5, s5, s6
s_add_u32 s83, s5, 524288
v_and_b32 v6, 1, v4
v_lshl_add_u32 v6, v5, 1, v6
v_lshlrev_b32 v6, 1, v6
v_lshrrev_b32 v7, 1, v4
v_lshl_add_u32 v6, v7, 6, v6
s_and_b32 s5, s81, 1
s_lshl_b32 s5, s5, 7
s_mul_i32 s6, s82, 384
s_add_u32 s5, s5, s6
s_add_u32 s5, s5, 99328
v_add_u32 v6, s5, v6
v_and_b32 v20, 1, v1
v_mul_u32_u24 v20, 384, v20
v_lshrrev_b32 v21, 4, v1
v_lshl_add_u32 v20, v21, 4, v20
v_add_u32 v20, 100352, v20
v_bfe_u32 v21, v1, 1, 1
v_lshl_add_u32 v20, v21, 6, v20
v_mov_b32 v21, 100000
v_cndmask_b32 v24, v21, v20, s[64:65]
v_cndmask_b32 v25, v21, v20, s[66:67]
v_cndmask_b32 v26, v21, v20, s[68:69]
v_cndmask_b32 v27, v21, v20, s[70:71]
v_mov_b32 v20, 0x4444
v_mov_b32 v21, 0xeeee
v_cndmask_b32 v20, v20, v21, s[72:73]
v_mov_b32 v84, 0
v_mov_b32 v85, 0
v_mov_b32 v86, 0
v_mov_b32 v87, 0
v_mov_b32 v88, 0
v_mov_b32 v89, 0
v_mov_b32 v90, 0
v_mov_b32 v91, 0
s_lshl_b32 s5, s81, 10
s_add_u32 s84, s80, s5
s_add_u32 s84, s84, 4096
v_mov_b32 v22, 101396
v_mov_b32 v23, 1
v_mov_b32 v44, 101380
s_mov_b32 s98, 0
LW_59:
ds_read_b32 v45, v44
s_waitcnt lgkmcnt(0)
v_readfirstlane_b32 s79, v45
s_nop 0
s_cmp_ge_u32 s79, 5
s_cbranch_scc1 LX_60
s_sleep 1
s_add_u32 s98, s98, 1
s_cmp_lt_u32 s98, 320000
s_cbranch_scc1 LW_59
LX_60:
s_mov_b32 s98, 0
LP_61:
buffer_load_dwordx2 v[52:53], v17, s[16:19], s85 offen sc1
buffer_load_dwordx2 v[54:55], v18, s[16:19], s85 offen sc1
buffer_load_dwordx2 v[56:57], v19, s[16:19], s85 offen sc1
s_waitcnt vmcnt(0)
v_max_u32 v16, v52, v53
v_max3_u32 v16, v16, v54, v55
v_max3_u32 v16, v16, v56, v57
v_cmp_eq_u32 vcc, -1, v16
s_cbranch_vccz LD_62
s_sleep 8
s_add_u32 s98, s98, 1
s_cmp_lt_u32 s98, 40000
s_cbranch_scc1 LP_61
LD_62:
v_lshlrev_b32 v17, 7, v8
v_lshlrev_b32 v18, 7, v9
v_lshlrev_b32 v19, 7, v10
s_lshl_b32 s5, s82, 3
s_lshr_b32 s6, s4, 2
s_add_u32 s5, s5, s6
s_mul_i32 s5, s5, 1536
s_and_b32 s6, s4, 3
s_lshl_b32 s6, s6, 3
s_add_u32 s5, s5, s6
s_add_u32 s85, s5, 917504
s_mov_b32 s98, 0
LP_64:
buffer_load_dwordx2 v[52:53], v17, s[16:19], s85 offen sc1
buffer_load_dwordx2 v[54:55], v18, s[16:19], s85 offen sc1
buffer_load_dwordx2 v[56:57], v19, s[16:19], s85 offen sc1
s_waitcnt vmcnt(0)
v_max_u32 v16, v52, v53
v_max3_u32 v16, v16, v54, v55
v_max3_u32 v16, v16, v56, v57
v_cmp_eq_u32 vcc, -1, v16
s_cbranch_vccz LD_65
s_sleep 1
s_add_u32 s98, s98, 1
s_cmp_lt_u32 s98, 40000
s_cbranch_scc1 LP_64
LD_65:
buffer_load_dwordx4 v[32:35], v12, s[16:19], s83 offen sc1
buffer_load_dwordx4 v[36:39], v13, s[16:19], s83 offen sc1
buffer_load_dwordx4 v[40:43], v14, s[16:19], s83 offen sc1
v_max3_f32 v16, v52, v54, v56
v_mov_b32 v17, v16
s_nop 1
v_permlane16_swap_b32 v16, v17
v_max_f32 v16, v16, v17
v_mov_b32 v17, v16
s_nop 1
v_permlane32_swap_b32 v16, v17
v_max_f32 v16, v16, v17
v_sub_f32 v48, v52, v16
v_sub_f32 v49, v54, v16
v_sub_f32 v50, v56, v16
v_mul_f32 v48, s77, v48
v_mul_f32 v49, s77, v49
v_mul_f32 v50, s77, v50
v_exp_f32 v48, v48
v_exp_f32 v49, v49
v_exp_f32 v50, v50
v_mul_f32 v16, v48, v53
v_fmac_f32 v16, v49, v55
v_fmac_f32 v16, v50, v57
v_mov_b32 v17, v16
s_nop 1
v_permlane16_swap_b32 v16, v17
v_add_f32 v16, v16, v17
v_mov_b32 v17, v16
s_nop 1
v_permlane32_swap_b32 v16, v17
v_add_f32 v16, v16, v17
v_rcp_f32 v16, v16
s_nop 0
v_mul_f32 v48, v48, v16
v_mul_f32 v49, v49, v16
v_mul_f32 v50, v50, v16
s_mov_b64 s[94:95], -1
s_mov_b32 s98, 0
s_branch LC_69
LP_67:
buffer_load_dwordx4 v[32:35], v12, s[16:19], s83 offen sc1
buffer_load_dwordx4 v[36:39], v13, s[16:19], s83 offen sc1
buffer_load_dwordx4 v[40:43], v14, s[16:19], s83 offen sc1
LC_69:
s_waitcnt vmcnt(0)
v_pk_mul_f32 v[28:29], v[32:33], v[48:49] op_sel_hi:[1,0]
v_pk_mul_f32 v[30:31], v[34:35], v[48:49] op_sel_hi:[1,0]
v_pk_fma_f32 v[28:29], v[36:37], v[48:49], v[28:29] op_sel:[0,1,0] op_sel_hi:[1,1,1]
v_pk_fma_f32 v[30:31], v[38:39], v[48:49], v[30:31] op_sel:[0,1,0] op_sel_hi:[1,1,1]
v_pk_fma_f32 v[28:29], v[40:41], v[50:51], v[28:29] op_sel_hi:[1,0,1]
v_pk_fma_f32 v[30:31], v[42:43], v[50:51], v[30:31] op_sel_hi:[1,0,1]
v_cmp_u_f32 vcc, v28, v29
v_cmp_u_f32 s[92:93], v30, v31
s_nop 0
s_or_b64 vcc, vcc, s[92:93]
s_cbranch_vccnz LD_68_r
LD_68:
v_permlane32_swap_b32 v28, v30
v_permlane32_swap_b32 v29, v31
v_add_f32 v28, v28, v30
v_add_f32 v29, v29, v31
s_nop 1
v_permlane16_swap_b32 v28, v29
v_add_f32 v28, v28, v29
v_cvt_pk_bf16_f32 v28, v28, v28
ds_write_b16 v6, v28
s_waitcnt lgkmcnt(0)
s_barrier
s_cmp_ge_u32 s4, 28
s_cbranch_scc1 L_b_end
s_waitcnt vmcnt(0)
s_barrier
s_barrier
ds_read_b128 v[60:63], v24
ds_read_b128 v[64:67], v25
ds_read_b128 v[68:71], v26
ds_read_b128 v[72:75], v27
s_waitcnt lgkmcnt(3)
v_smfmac_f32_16x16x64_bf16 v[84:87], v[60:63], v[96:103], v20
v_smfmac_f32_16x16x64_bf16 v[88:91], v[60:63], v[104:111], v20
s_waitcnt lgkmcnt(2)
v_smfmac_f32_16x16x64_bf16 v[84:87], v[64:67], v[112:119], v20
v_smfmac_f32_16x16x64_bf16 v[88:91], v[64:67], v[120:127], v20
s_waitcnt lgkmcnt(1)
v_smfmac_f32_16x16x64_bf16 v[84:87], v[68:71], v[128:135], v20
v_smfmac_f32_16x16x64_bf16 v[88:91], v[68:71], v[136:143], v20
s_waitcnt lgkmcnt(0)
v_smfmac_f32_16x16x64_bf16 v[84:87], v[72:75], v[144:151], v20
v_smfmac_f32_16x16x64_bf16 v[88:91], v[72:75], v[152:159], v20
s_cmp_eq_u32 s78, 2
s_nop 5
v_pk_add_f32 v[84:85], v[84:85], v[86:87]
v_pk_add_f32 v[86:87], v[88:89], v[90:91]
s_cbranch_scc0 LF_70
buffer_store_dwordx4 v[84:87], v2, s[16:19], s84 offen
LG_71:
L_b_end:
s_endpgm
LD_68_r:
s_add_u32 s98, s98, 1
s_and_b32 s5, s98, 31
s_cbranch_scc1 LP_67
v_max_u32 v16, v32, v33
v_max3_u32 v16, v16, v34, v35
v_max3_u32 v16, v16, v36, v37
v_max3_u32 v16, v16, v38, v39
v_max3_u32 v16, v16, v40, v41
v_max3_u32 v16, v16, v42, v43
v_cmp_eq_u32 vcc, -1, v16
s_cbranch_vccz LD_68
s_cmp_lt_u32 s98, 40000
s_cbranch_scc1 LP_67
s_branch LD_68
LF_70:
buffer_store_dwordx4 v[84:87], v2, s[16:19], s84 offen sc1
s_branch LG_71
L_tail_c:
s_mov_b32 s58, 0x300000
s_mov_b32 s59, 0x20000
s_mov_b32 s54, 0x800
s_mov_b32 s55, 0x20000
s_sub_u32 s81, s3, 8
v_lshrrev_b32 v5, 4, v1
v_mul_u32_u24 v5, 49152, v5
v_and_b32 v4, 15, v1
v_lshl_add_u32 v5, v4, 4, v5
v_and_b32 v6, 1, v1
v_mul_u32_u24 v6, 1024, v6
v_lshrrev_b32 v4, 4, v1
v_lshl_add_u32 v6, v4, 4, v6
s_and_b32 s5, s4, 3
s_lshl_b32 s5, s5, 7
s_lshl_b32 s6, s81, 5
s_add_u32 s83, s5, s6
s_mul_i32 s5, s83, 6144
s_lshr_b32 s6, s4, 2
s_lshl_b32 s6, s6, 8
s_add_u32 s84, s5, s6
s_lshl_b32 s83, s83, 1
s_waitcnt lgkmcnt(0)
buffer_load_dwordx4 v[156:159], v6, s[52:55], s83 offen
buffer_load_dwordx4 v[96:99], v5, s[56:59], s84 offen offset:0 nt
s_add_u32 s7, s84, 6144
buffer_load_dwordx4 v[100:103], v5, s[56:59], s7 offen nt
s_add_u32 s7, s84, 12288
buffer_load_dwordx4 v[104:107], v5, s[56:59], s7 offen nt
s_add_u32 s7, s84, 18432
buffer_load_dwordx4 v[108:111], v5, s[56:59], s7 offen nt
s_add_u32 s7, s84, 24576
buffer_load_dwordx4 v[112:115], v5, s[56:59], s7 offen nt
s_add_u32 s7, s84, 30720
buffer_load_dwordx4 v[116:119], v5, s[56:59], s7 offen nt
s_add_u32 s7, s84, 36864
buffer_load_dwordx4 v[120:123], v5, s[56:59], s7 offen nt
s_add_u32 s7, s84, 43008
buffer_load_dwordx4 v[124:127], v5, s[56:59], s7 offen nt
s_barrier
s_load_dwordx2 s[36:37], s[0:1], 48
s_load_dwordx2 s[40:41], s[0:1], 56
s_load_dwordx2 s[24:25], s[0:1], 0
s_load_dwordx2 s[48:49], s[0:1], 72
s_mov_b32 s38, 0x1c0000
s_mov_b32 s39, 0x20000
s_mov_b32 s42, 0xe00
s_mov_b32 s43, 0x20000
s_mov_b32 s26, 0x800
s_mov_b32 s27, 0x20000
s_mov_b32 s50, 0x400
s_mov_b32 s51, 0x20000
s_mov_b32 s64, 0xf000f
s_mov_b32 s65, 0xf000f
s_mov_b32 s66, 0xf000f0
s_mov_b32 s67, 0xf000f0
s_mov_b32 s68, 0xf000f00
s_mov_b32 s69, 0xf000f00
s_mov_b32 s70, 0xf000f000
s_mov_b32 s71, 0xf000f000
s_mov_b32 s72, 0xcccccccc
s_mov_b32 s73, 0xcccccccc
s_mov_b32 s74, 0x05040100
s_mov_b32 s75, 0x07060302
s_mov_b32 s76, 0xffff0000
s_mov_b32 s77, 0x3fb8aa3b
s_mul_i32 s80, s4, 14976
s_add_u32 s80, s80, 32768
v_lshlrev_b32 v2, 4, v1
s_load_dword s96, s[16:17], 0x0
s_waitcnt vmcnt(8)
s_mov_b32 s99, 0x7e800000
v_lshlrev_b32 v8, 16, v156
v_and_b32 v9, s76, v156
v_mul_f32 v10, s77, v8
v_mul_f32 v11, s77, v9
v_exp_f32 v10, -v10
v_exp_f32 v11, -v11
v_add_f32 v10, 1.0, v10
v_add_f32 v11, 1.0, v11
v_rcp_f32 v12, v10
v_rcp_f32 v13, v11
v_mul_f32 v14, v8, v12
v_mul_f32 v15, v9, v13
v_cmp_gt_f32 s[88:89], s99, v10
v_fma_f32 v8, -v14, v10, v8
v_fma_f32 v8, v8, v12, v14
v_cndmask_b32 v8, v14, v8, s[88:89]
v_cmp_gt_f32 s[90:91], s99, v11
v_fma_f32 v9, -v15, v11, v9
v_fma_f32 v9, v9, v13, v15
v_cndmask_b32 v9, v15, v9, s[90:91]
v_cvt_pk_bf16_f32 v156, v8, v9
v_lshlrev_b32 v8, 16, v157
v_and_b32 v9, s76, v157
v_mul_f32 v10, s77, v8
v_mul_f32 v11, s77, v9
v_exp_f32 v10, -v10
v_exp_f32 v11, -v11
v_add_f32 v10, 1.0, v10
v_add_f32 v11, 1.0, v11
v_rcp_f32 v12, v10
v_rcp_f32 v13, v11
v_mul_f32 v14, v8, v12
v_mul_f32 v15, v9, v13
v_cmp_gt_f32 s[88:89], s99, v10
v_fma_f32 v8, -v14, v10, v8
v_fma_f32 v8, v8, v12, v14
v_cndmask_b32 v8, v14, v8, s[88:89]
v_cmp_gt_f32 s[90:91], s99, v11
v_fma_f32 v9, -v15, v11, v9
v_fma_f32 v9, v9, v13, v15
v_cndmask_b32 v9, v15, v9, s[90:91]
v_cvt_pk_bf16_f32 v157, v8, v9
v_lshlrev_b32 v8, 16, v158
v_and_b32 v9, s76, v158
v_mul_f32 v10, s77, v8
v_mul_f32 v11, s77, v9
v_exp_f32 v10, -v10
v_exp_f32 v11, -v11
v_add_f32 v10, 1.0, v10
v_add_f32 v11, 1.0, v11
v_rcp_f32 v12, v10
v_rcp_f32 v13, v11
v_mul_f32 v14, v8, v12
v_mul_f32 v15, v9, v13
v_cmp_gt_f32 s[88:89], s99, v10
v_fma_f32 v8, -v14, v10, v8
v_fma_f32 v8, v8, v12, v14
v_cndmask_b32 v8, v14, v8, s[88:89]
v_cmp_gt_f32 s[90:91], s99, v11
v_fma_f32 v9, -v15, v11, v9
v_fma_f32 v9, v9, v13, v15
v_cndmask_b32 v9, v15, v9, s[90:91]
v_cvt_pk_bf16_f32 v158, v8, v9
v_lshlrev_b32 v8, 16, v159
v_and_b32 v9, s76, v159
v_mul_f32 v10, s77, v8
v_mul_f32 v11, s77, v9
v_exp_f32 v10, -v10
v_exp_f32 v11, -v11
v_add_f32 v10, 1.0, v10
v_add_f32 v11, 1.0, v11
v_rcp_f32 v12, v10
v_rcp_f32 v13, v11
v_mul_f32 v14, v8, v12
v_mul_f32 v15, v9, v13
v_cmp_gt_f32 s[88:89], s99, v10
v_fma_f32 v8, -v14, v10, v8
v_fma_f32 v8, v8, v12, v14
v_cndmask_b32 v8, v14, v8, s[88:89]
v_cmp_gt_f32 s[90:91], s99, v11
v_fma_f32 v9, -v15, v11, v9
v_fma_f32 v9, v9, v13, v15
v_cndmask_b32 v9, v15, v9, s[90:91]
v_cvt_pk_bf16_f32 v159, v8, v9
s_waitcnt vmcnt(0)
v_cndmask_b32 v8, 0, v156, s[64:65]
v_cndmask_b32 v9, 0, v157, s[64:65]
v_cndmask_b32 v10, 0, v158, s[64:65]
v_cndmask_b32 v11, 0, v159, s[64:65]
v_perm_b32 v12, v100, v96, s74
v_perm_b32 v13, v108, v104, s74
v_perm_b32 v14, v116, v112, s74
v_perm_b32 v15, v124, v120, s74
v_perm_b32 v16, v100, v96, s75
v_perm_b32 v17, v108, v104, s75
v_perm_b32 v18, v116, v112, s75
v_perm_b32 v19, v124, v120, s75
v_mfma_f32_16x16x32_bf16 v[20:23], v[12:15], v[8:11], 0
s_nop 0
v_mfma_f32_16x16x32_bf16 v[24:27], v[16:19], v[8:11], 0
v_cndmask_b32 v8, 0, v156, s[66:67]
v_cndmask_b32 v9, 0, v157, s[66:67]
v_cndmask_b32 v10, 0, v158, s[66:67]
v_cndmask_b32 v11, 0, v159, s[66:67]
v_perm_b32 v12, v101, v97, s74
v_perm_b32 v13, v109, v105, s74
v_perm_b32 v14, v117, v113, s74
v_perm_b32 v15, v125, v121, s74
v_perm_b32 v16, v101, v97, s75
v_perm_b32 v17, v109, v105, s75
v_perm_b32 v18, v117, v113, s75
v_perm_b32 v19, v125, v121, s75
v_mfma_f32_16x16x32_bf16 v[20:23], v[12:15], v[8:11], v[20:23]
s_nop 0
v_mfma_f32_16x16x32_bf16 v[24:27], v[16:19], v[8:11], v[24:27]
v_cndmask_b32 v8, 0, v156, s[68:69]
v_cndmask_b32 v9, 0, v157, s[68:69]
v_cndmask_b32 v10, 0, v158, s[68:69]
v_cndmask_b32 v11, 0, v159, s[68:69]
v_perm_b32 v12, v102, v98, s74
v_perm_b32 v13, v110, v106, s74
v_perm_b32 v14, v118, v114, s74
v_perm_b32 v15, v126, v122, s74
v_perm_b32 v16, v102, v98, s75
v_perm_b32 v17, v110, v106, s75
v_perm_b32 v18, v118, v114, s75
v_perm_b32 v19, v126, v122, s75
v_mfma_f32_16x16x32_bf16 v[20:23], v[12:15], v[8:11], v[20:23]
s_nop 0
v_mfma_f32_16x16x32_bf16 v[24:27], v[16:19], v[8:11], v[24:27]
v_cndmask_b32 v8, 0, v156, s[70:71]
v_cndmask_b32 v9, 0, v157, s[70:71]
v_cndmask_b32 v10, 0, v158, s[70:71]
v_cndmask_b32 v11, 0, v159, s[70:71]
v_perm_b32 v12, v103, v99, s74
v_perm_b32 v13, v111, v107, s74
v_perm_b32 v14, v119, v115, s74
v_perm_b32 v15, v127, v123, s74
v_perm_b32 v16, v103, v99, s75
v_perm_b32 v17, v111, v107, s75
v_perm_b32 v18, v119, v115, s75
v_perm_b32 v19, v127, v123, s75
v_mfma_f32_16x16x32_bf16 v[20:23], v[12:15], v[8:11], v[20:23]
s_nop 0
v_mfma_f32_16x16x32_bf16 v[24:27], v[16:19], v[8:11], v[24:27]
s_lshl_b32 s5, s81, 10
s_add_u32 s5, s5, 80128
v_add_u32 v4, s5, v2
s_nop 4
v_cndmask_b32 v20, v20, v24, s[72:73]
v_cndmask_b32 v21, v21, v25, s[72:73]
v_cndmask_b32 v22, v22, v26, s[72:73]
v_cndmask_b32 v23, v23, v27, s[72:73]
ds_write_b128 v4, v[20:23]
v_mov_b32 v8, 101388
v_mov_b32 v9, 1
s_mov_b64 exec, 1
ds_add_u32 v8, v9
s_mov_b64 exec, -1
s_cmp_lg_u32 s3, 8
s_cbranch_scc1 L_c_w1
s_waitcnt lgkmcnt(0)
s_mul_i32 s97, s96, 0x9e3779b1
s_add_u32 s97, s97, 0x85ebca6b
v_mov_b32 v33, s97
v_mov_b32 v35, s97
v_mov_b32 v37, s97
v_mov_b32 v39, s97
v_mov_b32 v8, 101388
s_mov_b32 s98, 0
LW_72:
ds_read_b32 v9, v8
s_waitcnt lgkmcnt(0)
v_readfirstlane_b32 s79, v9
s_nop 0
s_cmp_ge_u32 s79, 4
s_cbranch_scc1 LX_73
s_sleep 1
s_add_u32 s98, s98, 1
s_cmp_lt_u32 s98, 320000
s_cbranch_scc1 LW_72
LX_73:
v_add_u32 v3, 80128, v2
ds_read_b128 v[96:99], v3 offset:0
ds_read_b128 v[100:103], v3 offset:1024
ds_read_b128 v[104:107], v3 offset:2048
ds_read_b128 v[108:111], v3 offset:3072
s_waitcnt lgkmcnt(0)
v_add_f32 v96, v96, v100
v_add_f32 v97, v97, v101
v_add_f32 v98, v98, v102
v_add_f32 v99, v99, v103
v_add_f32 v96, v96, v104
v_add_f32 v97, v97, v105
v_add_f32 v98, v98, v106
v_add_f32 v99, v99, v107
v_add_f32 v96, v96, v108
v_add_f32 v97, v97, v109
v_add_f32 v98, v98, v110
v_add_f32 v99, v99, v111
v_mov_b32 v32, v96
v_mov_b32 v34, v97
v_mov_b32 v36, v98
v_mov_b32 v38, v99
s_add_u32 s5, s80, 10752
buffer_store_dwordx4 v[32:35], v2, s[16:19], s5 offen
buffer_store_dwordx4 v[36:39], v2, s[16:19], s5 offen offset:1024
buffer_store_dwordx4 v[32:35], v2, s[16:19], s5 offen offset:2048 sc1
buffer_store_dwordx4 v[36:39], v2, s[16:19], s5 offen offset:3072 sc1
v_mov_b32 v8, 101392
v_mov_b32 v9, 1
s_mov_b64 exec, 1
ds_add_u32 v8, v9
s_mov_b64 exec, -1
L_c_w1:
v_mov_b32 v8, 101392
s_mov_b32 s98, 0
LW_74:
ds_read_b32 v9, v8
s_waitcnt lgkmcnt(0)
v_readfirstlane_b32 s79, v9
s_nop 0
s_cmp_ge_u32 s79, 1
s_cbranch_scc1 LX_75
s_sleep 1
s_add_u32 s98, s98, 1
s_cmp_lt_u32 s98, 320000
s_cbranch_scc1 LW_74
LX_75:
s_cmp_eq_u32 s3, 8
s_cbranch_scc1 L_c_fin
s_cmp_lg_u32 s3, 10
s_cbranch_scc1 L_c_nf
s_getreg_b32 s5, hwreg(HW_REG_XCC_ID)
s_and_b32 s5, s5, 7
s_mul_i32 s6, s5, s5
s_lshl_b32 s6, s6, 16
s_lshl_b32 s5, s5, 8
s_add_u32 s5, s5, s6
s_add_u32 s85, s5, 1
v_mov_b32 v13, 0
s_mov_b64 exec, 1
s_cmp_lg_u32 s4, 0
s_cbranch_scc1 L_b_fl
s_mov_b32 s98, 0
LC_76:
buffer_load_dword v14, v13, s[20:23], 0 offen offset:4 sc1
s_waitcnt vmcnt(0)
v_and_b32 v15, 63, v14
v_cmp_gt_u32 vcc, 32, v15
s_cbranch_vccz LE_77
s_sleep 1
s_add_u32 s98, s98, 1
s_cmp_lt_u32 s98, 40000
s_cbranch_scc1 LC_76
LE_77:
v_readfirstlane_b32 s6, v14
s_lshl_b32 s85, s85, 5
s_cmp_eq_u32 s85, s6
s_cselect_b32 s85, 2, 1
s_mov_b32 s98, 0
LC_78:
buffer_load_dword v14, v13, s[20:23], 0 offen offset:0 sc1
s_waitcnt vmcnt(0)
v_and_b32 v15, 63, v14
v_cmp_gt_u32 vcc, 32, v15
s_cbranch_vccz LE_79
s_sleep 1
s_add_u32 s98, s98, 1
s_cmp_lt_u32 s98, 40000
s_cbranch_scc1 LC_78
LE_79:
v_mov_b32 v16, s85
buffer_store_dword v16, v13, s[20:23], 0 offen offset:128 sc1
s_branch L_b_fm
L_b_fl:
s_mov_b32 s98, 0
LP_80:
buffer_load_dword v16, v13, s[20:23], 0 offen offset:128 sc1
s_waitcnt vmcnt(0)
v_cmp_eq_u32 vcc, 0, v16
s_cbranch_vccz LD_81
s_sleep 8
s_add_u32 s98, s98, 1
s_cmp_lt_u32 s98, 40000
s_cbranch_scc1 LP_80
LD_81:
L_b_fm:
v_readfirstlane_b32 s5, v16
s_mov_b64 exec, -1
v_mov_b32 v8, 101376
v_mov_b32 v9, s5
s_mov_b64 exec, 1
ds_add_u32 v8, v9
s_mov_b64 exec, -1
L_c_nf:
v_mov_b32 v8, 101376
s_mov_b32 s98, 0
LW_83:
ds_read_b32 v9, v8
s_waitcnt lgkmcnt(0)
v_readfirstlane_b32 s78, v9
s_nop 0
s_cmp_ge_u32 s78, 1
s_cbranch_scc1 LX_84
s_sleep 1
s_add_u32 s98, s98, 1
s_cmp_lt_u32 s98, 320000
s_cbranch_scc1 LW_83
LX_84:
v_mov_b32 v8, 101380
s_mov_b32 s98, 0
LW_85:
ds_read_b32 v9, v8
s_waitcnt lgkmcnt(0)
v_readfirstlane_b32 s79, v9
s_nop 0
s_cmp_ge_u32 s79, 5
s_cbranch_scc1 LX_86
s_sleep 1
s_add_u32 s98, s98, 1
s_cmp_lt_u32 s98, 320000
s_cbranch_scc1 LW_85
LX_86:
s_cmp_lg_u32 s3, 9
s_cbranch_scc1 L_c_img
v_and_b32 v4, 7, v1
v_lshrrev_b32 v5, 4, v1
s_and_b32 s5, s4, 0x18
s_lshl_b32 s5, s5, 5
s_and_b32 s6, s4, 1
s_lshl_b32 s6, s6, 7
s_add_u32 s5, s5, s6
s_and_b32 s6, s4, 6
s_lshl_b32 s6, s6, 1
s_add_u32 s84, s5, s6
v_lshlrev_b32 v6, 3, v4
v_lshrrev_b32 v7, 1, v5
v_add_u32 v6, v6, v7
v_lshlrev_b32 v6, 1, v6
v_and_b32 v7, 1, v5
v_lshl_add_u32 v7, v7, 10, v6
buffer_load_ushort v113, v7, s[24:27], s84 offen
buffer_load_ushort v115, v6, s[48:51], s84 offen
v_lshrrev_b32 v6, 2, v4
v_lshlrev_b32 v6, 8, v6
v_lshl_add_u32 v6, v5, 4, v6
v_and_b32 v7, 3, v4
v_lshl_add_u32 v6, v7, 2, v6
s_lshr_b32 s5, s4, 3
s_mul_i32 s5, s5, 29952
s_and_b32 s6, s4, 1
s_lshl_b32 s6, s6, 9
s_add_u32 s5, s5, s6
s_and_b32 s6, s4, 6
s_lshl_b32 s6, s6, 5
s_add_u32 s5, s5, s6
s_add_u32 s85, s5, 40960
s_mov_b32 s98, 0
LP_87:
s_add_u32 s6, s85, 0
buffer_load_dword v96, v6, s[16:19], s6 offen sc1
s_add_u32 s6, s85, 14976
buffer_load_dword v97, v6, s[16:19], s6 offen sc1
s_add_u32 s6, s85, 359424
buffer_load_dword v98, v6, s[16:19], s6 offen sc1
s_add_u32 s6, s85, 374400
buffer_load_dword v99, v6, s[16:19], s6 offen sc1
s_waitcnt vmcnt(0)
v_max_u32 v8, v96, v97
v_max3_u32 v8, v8, v98, v99
v_cmp_eq_u32 vcc, -1, v8
s_cbranch_vccz LD_88
s_sleep 16
s_add_u32 s98, s98, 1
s_cmp_lt_u32 s98, 40000
s_cbranch_scc1 LP_87
LD_88:
v_add_f32 v112, v96, v97
v_add_f32 v114, v98, v99
v_cvt_pk_bf16_f32 v8, v112, v114
v_lshlrev_b32 v112, 16, v8
v_and_b32 v114, s76, v8
v_lshlrev_b32 v113, 16, v113
v_lshlrev_b32 v115, 16, v115
v_lshlrev_b32 v5, 2, v5
v_lshl_add_u32 v5, v4, 4, v5
v_add_u32 v5, 100864, v5
ds_write_b32 v5, v112 offset:0
ds_write_b32 v5, v113 offset:128
ds_write_b32 v5, v114 offset:256
ds_write_b32 v5, v115 offset:384
s_branch L_c_fin
L_c_img:
s_sub_u32 s5, s3, 10
s_lshl_b32 s5, s5, 4
v_and_b32 v4, 31, v1
v_lshlrev_b32 v4, 5, v4
v_lshrrev_b32 v5, 5, v1
v_mul_u32_u24 v5, 29952, v5
v_add_u32 v4, v4, v5
v_add_u32 v4, s5, v4
v_lshlrev_b32 v5, 5, v1
v_add_u32 v5, s5, v5
v_add_u32 v5, 88320, v5
s_mov_b32 s98, 0
LP_90:
s_mov_b32 s6, 160768
buffer_load_dwordx4 v[96:99], v4, s[16:19], s6 offen sc1
s_mov_b32 s6, 175744
buffer_load_dwordx4 v[100:103], v4, s[16:19], s6 offen sc1
s_mov_b32 s6, 220672
buffer_load_dwordx4 v[104:107], v4, s[16:19], s6 offen sc1
s_mov_b32 s6, 235648
buffer_load_dwordx4 v[108:111], v4, s[16:19], s6 offen sc1
s_mov_b32 s6, 280576
buffer_load_dwordx4 v[112:115], v4, s[16:19], s6 offen sc1
s_mov_b32 s6, 295552
buffer_load_dwordx4 v[116:119], v4, s[16:19], s6 offen sc1
s_mov_b32 s6, 340480
buffer_load_dwordx4 v[120:123], v4, s[16:19], s6 offen sc1
s_mov_b32 s6, 355456
buffer_load_dwordx4 v[124:127], v4, s[16:19], s6 offen sc1
s_waitcnt vmcnt(0)
v_max_u32 v8, v96, v97
v_max3_u32 v8, v8, v98, v99
v_max3_u32 v8, v8, v100, v101
v_max3_u32 v8, v8, v102, v103
v_max3_u32 v8, v8, v104, v105
v_max3_u32 v8, v8, v106, v107
v_max3_u32 v8, v8, v108, v109
v_max3_u32 v8, v8, v110, v111
v_max3_u32 v8, v8, v112, v113
v_max3_u32 v8, v8, v114, v115
v_max3_u32 v8, v8, v116, v117
v_max3_u32 v8, v8, v118, v119
v_max3_u32 v8, v8, v120, v121
v_max3_u32 v8, v8, v122, v123
v_max3_u32 v8, v8, v124, v125
v_max3_u32 v8, v8, v126, v127
v_cmp_eq_u32 vcc, -1, v8
s_cbranch_vccz LD_91
s_sleep 16
s_add_u32 s98, s98, 1
s_cmp_lt_u32 s98, 40000
s_cbranch_scc1 LP_90
LD_91:
v_add_f32 v128, v96, v100
v_add_f32 v129, v97, v101
v_add_f32 v130, v98, v102
v_add_f32 v131, v99, v103
v_add_f32 v132, v104, v108
v_add_f32 v133, v105, v109
v_add_f32 v134, v106, v110
v_add_f32 v135, v107, v111
v_add_f32 v136, v112, v116
v_add_f32 v137, v113, v117
v_add_f32 v138, v114, v118
v_add_f32 v139, v115, v119
v_add_f32 v140, v120, v124
v_add_f32 v141, v121, v125
v_add_f32 v142, v122, v126
v_add_f32 v143, v123, v127
v_cvt_pk_bf16_f32 v8, v128, v129
v_lshlrev_b32 v128, 16, v8
v_and_b32 v129, s76, v8
v_cvt_pk_bf16_f32 v8, v130, v131
v_lshlrev_b32 v130, 16, v8
v_and_b32 v131, s76, v8
v_cvt_pk_bf16_f32 v8, v132, v133
v_lshlrev_b32 v132, 16, v8
v_and_b32 v133, s76, v8
v_cvt_pk_bf16_f32 v8, v134, v135
v_lshlrev_b32 v134, 16, v8
v_and_b32 v135, s76, v8
v_cvt_pk_bf16_f32 v8, v136, v137
v_lshlrev_b32 v136, 16, v8
v_and_b32 v137, s76, v8
v_cvt_pk_bf16_f32 v8, v138, v139
v_lshlrev_b32 v138, 16, v8
v_and_b32 v139, s76, v8
v_cvt_pk_bf16_f32 v8, v140, v141
v_lshlrev_b32 v140, 16, v8
v_and_b32 v141, s76, v8
v_cvt_pk_bf16_f32 v8, v142, v143
v_lshlrev_b32 v142, 16, v8
v_and_b32 v143, s76, v8
v_add_f32 v136, 1.0, v136
v_add_f32 v137, 1.0, v137
v_add_f32 v138, 1.0, v138
v_add_f32 v139, 1.0, v139
v_add_f32 v140, 1.0, v140
v_add_f32 v141, 1.0, v141
v_add_f32 v142, 1.0, v142
v_add_f32 v143, 1.0, v143
v_cvt_pk_bf16_f32 v8, v136, v137
v_lshlrev_b32 v136, 16, v8
v_and_b32 v137, s76, v8
v_cvt_pk_bf16_f32 v8, v138, v139
v_lshlrev_b32 v138, 16, v8
v_and_b32 v139, s76, v8
v_cvt_pk_bf16_f32 v8, v140, v141
v_lshlrev_b32 v140, 16, v8
v_and_b32 v141, s76, v8
v_cvt_pk_bf16_f32 v8, v142, v143
v_lshlrev_b32 v142, 16, v8
v_and_b32 v143, s76, v8
v_add_f32 v10, v128, v129
v_add_f32 v10, v10, v130
v_add_f32 v10, v10, v131
v_add_f32 v10, v10, v132
v_add_f32 v10, v10, v133
v_add_f32 v10, v10, v134
v_add_f32 v10, v10, v135
s_nop 1
v_add_f32_dpp v10, v10, v10 row_ror:8 row_mask:0xf bank_mask:0xf
s_nop 1
v_add_f32_dpp v10, v10, v10 row_ror:4 row_mask:0xf bank_mask:0xf
s_nop 1
v_add_f32_dpp v10, v10, v10 row_ror:2 row_mask:0xf bank_mask:0xf
s_nop 1
v_add_f32_dpp v10, v10, v10 row_ror:1 row_mask:0xf bank_mask:0xf
v_mov_b32 v11, v10
s_nop 1
v_permlane16_swap_b32 v10, v11
v_add_f32 v10, v10, v11
v_mov_b32 v11, v10
s_nop 1
v_permlane32_swap_b32 v10, v11
v_add_f32 v10, v10, v11
v_mul_f32 v10, 0x3b000000, v10
v_sub_f32 v128, v128, v10
v_sub_f32 v129, v129, v10
v_sub_f32 v130, v130, v10
v_sub_f32 v131, v131, v10
v_sub_f32 v132, v132, v10
v_sub_f32 v133, v133, v10
v_sub_f32 v134, v134, v10
v_sub_f32 v135, v135, v10
ds_write_b128 v5, v[136:139]
ds_write_b128 v5, v[140:143] offset:2048
ds_write_b128 v5, v[128:131] offset:4096
ds_write_b128 v5, v[132:135] offset:6144
L_c_fin:
s_cmp_ge_u32 s4, 28
s_cbranch_scc1 L_c_last
v_bfe_u32 v3, v1, 3, 2
v_lshlrev_b32 v3, 3, v3
v_lshrrev_b32 v4, 5, v1
v_add_u32 v3, v3, v4
v_mul_u32_u24 v3, 3584, v3
v_and_b32 v4, 7, v1
v_lshl_add_u32 v3, v4, 4, v3
s_cmp_lg_u32 s3, 8
s_cbranch_scc1 L_c_b1
s_lshl_b32 s82, s4, 7
s_mov_b32 s83, 0
L_c_dma:
s_add_u32 m0, s83, 0
s_waitcnt vmcnt(11)
buffer_load_dwordx4 v3, s[36:39], s82 offen nt lds
s_add_u32 s5, s82, 7168
s_add_u32 m0, s83, 1024
s_waitcnt vmcnt(11)
buffer_load_dwordx4 v3, s[36:39], s5 offen nt lds
s_add_u32 s5, s82, 14336
s_add_u32 m0, s83, 2048
s_waitcnt vmcnt(11)
buffer_load_dwordx4 v3, s[36:39], s5 offen nt lds
s_add_u32 s5, s82, 21504
s_add_u32 m0, s83, 3072
s_waitcnt vmcnt(11)
buffer_load_dwordx4 v3, s[36:39], s5 offen nt lds
s_add_u32 s82, s82, 114688
s_add_u32 s83, s83, 4096
s_cmp_lt_u32 s83, 65536
s_cbranch_scc1 L_c_dma
v_mov_b32 v8, 101380
v_mov_b32 v9, 1
s_mov_b64 exec, 1
ds_add_u32 v8, v9
s_mov_b64 exec, -1
L_c_b1:
v_and_b32 v4, 15, v1
v_lshlrev_b32 v4, 1, v4
s_lshl_b32 s5, s4, 7
s_lshl_b32 s6, s81, 5
s_add_u32 s5, s5, s6
buffer_load_ushort v24, v4, s[40:43], s5 offen
s_waitcnt lgkmcnt(0)
s_barrier
s_waitcnt vmcnt(0)
v_mov_b32 v8, 101404
v_mov_b32 v9, 1
s_mov_b64 exec, 1
ds_add_u32 v8, v9
s_mov_b64 exec, -1
v_mov_b32 v8, 101404
s_mov_b32 s98, 0
LW_93:
ds_read_b32 v9, v8
s_waitcnt lgkmcnt(0)
v_readfirstlane_b32 s79, v9
s_nop 0
s_cmp_ge_u32 s79, 4
s_cbranch_scc1 LX_94
s_sleep 1
s_add_u32 s98, s98, 1
s_cmp_lt_u32 s98, 320000
s_cbranch_scc1 LW_93
LX_94:
v_lshrrev_b32 v3, 4, v1
v_lshlrev_b32 v3, 10, v3
v_bfe_u32 v4, v1, 2, 2
v_lshl_add_u32 v3, v4, 7, v3
v_and_b32 v4, 3, v1
v_lshl_add_u32 v3, v4, 3, v3
s_lshl_b32 s5, s81, 5
v_add_u32 v3, s5, v3
ds_read_b64_tr_b16 v[32:33], v3 offset:0
ds_read_b64_tr_b16 v[34:35], v3 offset:512
ds_read_b64_tr_b16 v[36:37], v3 offset:4096
ds_read_b64_tr_b16 v[38:39], v3 offset:4608
ds_read_b64_tr_b16 v[40:41], v3 offset:8192
ds_read_b64_tr_b16 v[42:43], v3 offset:8704
ds_read_b64_tr_b16 v[44:45], v3 offset:12288
ds_read_b64_tr_b16 v[46:47], v3 offset:12800
s_waitcnt lgkmcnt(0)
ds_read_b64_tr_b16 v[48:49], v3 offset:16384
ds_read_b64_tr_b16 v[50:51], v3 offset:16896
ds_read_b64_tr_b16 v[52:53], v3 offset:20480
ds_read_b64_tr_b16 v[54:55], v3 offset:20992
ds_read_b64_tr_b16 v[56:57], v3 offset:24576
ds_read_b64_tr_b16 v[58:59], v3 offset:25088
ds_read_b64_tr_b16 v[60:61], v3 offset:28672
ds_read_b64_tr_b16 v[62:63], v3 offset:29184
s_waitcnt lgkmcnt(0)
ds_read_b64_tr_b16 v[64:65], v3 offset:32768
ds_read_b64_tr_b16 v[66:67], v3 offset:33280
ds_read_b64_tr_b16 v[68:69], v3 offset:36864
ds_read_b64_tr_b16 v[70:71], v3 offset:37376
ds_read_b64_tr_b16 v[72:73], v3 offset:40960
ds_read_b64_tr_b16 v[74:75], v3 offset:41472
ds_read_b64_tr_b16 v[76:77], v3 offset:45056
ds_read_b64_tr_b16 v[78:79], v3 offset:45568
s_waitcnt lgkmcnt(0)
ds_read_b64_tr_b16 v[80:81], v3 offset:49152
ds_read_b64_tr_b16 v[82:83], v3 offset:49664
ds_read_b64_tr_b16 v[84:85], v3 offset:53248
ds_read_b64_tr_b16 v[86:87], v3 offset:53760
ds_read_b64_tr_b16 v[88:89], v3 offset:57344
ds_read_b64_tr_b16 v[90:91], v3 offset:57856
ds_read_b64_tr_b16 v[92:93], v3 offset:61440
ds_read_b64_tr_b16 v[94:95], v3 offset:61952
s_waitcnt lgkmcnt(0)
v_lshlrev_b32 v20, 16, v24
v_mov_b32 v21, v20
v_mov_b32 v22, 0
v_mov_b32 v23, 0
v_mov_b32 v24, 0
v_mov_b32 v25, 0
v_mov_b32 v26, 0
v_mov_b32 v27, 0
v_and_b32 v3, 1, v1
v_mul_u32_u24 v3, 1152, v3
v_lshrrev_b32 v4, 4, v1
v_lshl_add_u32 v3, v4, 4, v3
v_add_u32 v3, 96512, v3
v_bfe_u32 v4, v1, 1, 1
v_lshl_add_u32 v3, v4, 6, v3
v_mov_b32 v6, 0x4444
v_mov_b32 v7, 0xeeee
v_cndmask_b32 v6, v6, v7, s[72:73]
v_bfe_u32 v4, v1, 1, 1
v_lshlrev_b32 v4, 6, v4
v_bfe_u32 v5, v1, 2, 2
v_lshl_add_u32 v4, v5, 2, v4
v_and_b32 v5, 1, v1
v_lshl_add_u32 v4, v5, 1, v4
s_lshl_b32 s5, s81, 4
s_add_u32 s5, s5, 100352
v_add_u32 v4, s5, v4
s_mov_b32 s82, 0xc0135761
v_mov_b32 v5, 0xbdd2d3e8
s_mov_b64 s[94:95], -1
s_barrier
ds_read_b128 v[96:99], v3 offset:0
ds_read_b128 v[100:103], v3 offset:128
ds_read_b128 v[104:107], v3 offset:256
ds_read_b128 v[108:111], v3 offset:384
ds_read_b128 v[112:115], v3 offset:512
ds_read_b128 v[116:119], v3 offset:640
ds_read_b128 v[120:123], v3 offset:768
ds_read_b128 v[124:127], v3 offset:896
s_waitcnt lgkmcnt(7)
v_smfmac_f32_16x16x64_bf16 v[20:23], v[96:99], v[32:39], v6
s_waitcnt lgkmcnt(6)
v_smfmac_f32_16x16x64_bf16 v[20:23], v[100:103], v[40:47], v6
s_waitcnt lgkmcnt(5)
v_smfmac_f32_16x16x64_bf16 v[20:23], v[104:107], v[48:55], v6
s_waitcnt lgkmcnt(4)
v_smfmac_f32_16x16x64_bf16 v[20:23], v[108:111], v[56:63], v6
s_waitcnt lgkmcnt(3)
v_smfmac_f32_16x16x64_bf16 v[20:23], v[112:115], v[64:71], v6
s_waitcnt lgkmcnt(2)
v_smfmac_f32_16x16x64_bf16 v[20:23], v[116:119], v[72:79], v6
s_waitcnt lgkmcnt(1)
v_smfmac_f32_16x16x64_bf16 v[20:23], v[120:123], v[80:87], v6
s_waitcnt lgkmcnt(0)
v_smfmac_f32_16x16x64_bf16 v[20:23], v[124:127], v[88:95], v6
s_and_b32 exec_lo, 0xffff, s94
s_and_b32 exec_hi, 0x0, s95
s_nop 5
v_pk_add_f32 v[20:21], v[20:21], v[22:23]
v_mul_f32 v8, v20, v20
v_mul_f32 v9, v21, v21
v_fma_f32 v8, v8, v5, s82
v_fma_f32 v9, v9, v5, s82
v_mul_f32 v8, v8, v20
v_mul_f32 v9, v9, v21
v_exp_f32 v8, v8
v_exp_f32 v9, v9
v_add_f32 v8, 1.0, v8
v_add_f32 v9, 1.0, v9
v_rcp_f32 v8, v8
v_rcp_f32 v9, v9
v_mul_f32 v8, v8, v20
v_mul_f32 v9, v9, v21
v_cvt_pk_bf16_f32 v8, v8, v9
ds_write_b16 v4, v8
ds_write_b16_d16_hi v4, v8 offset:384
s_waitcnt lgkmcnt(0)
s_barrier
s_endpgm
L_c_last:
s_cmp_lg_u32 s3, 8
s_cbranch_scc1 L_c_l2
v_mov_b32 v8, 101380
v_mov_b32 v9, 1
s_mov_b64 exec, 1
ds_add_u32 v8, v9
s_mov_b64 exec, -1
L_c_l2:
s_waitcnt lgkmcnt(0)
s_barrier
s_endpgm
L_exit:
s_endpgm
.section .rodata,"a"
.p2align 6
.amdhsa_kernel adaLN_cond__gqa_block_cached__mixer_channel_mlp__decode_kernel
  .amdhsa_next_free_vgpr 168
  .amdhsa_next_free_sgpr 102
  .amdhsa_accum_offset 168
  .amdhsa_group_segment_fixed_size 0
  .amdhsa_kernarg_size 120
  .amdhsa_user_sgpr_count 2
  .amdhsa_user_sgpr_kernarg_segment_ptr 1
  .amdhsa_system_sgpr_workgroup_id_x 1
.end_amdhsa_kernel
```
